```python
import torch

def _softmax(x, axis=-1):
    return torch.softmax(x, dim=axis)

def _gelu(x):
    return torch.nn.functional.gelu(x, approximate='tanh')

def _silu(x):
    return torch.nn.functional.silu(x)

def _sigmoid(x):
    return torch.sigmoid(x)

def _layernorm(x, axis=-1, eps=1e-05):
    m = x.mean(dim=axis, keepdim=True)
    v = x.var(dim=axis, keepdim=True, unbiased=False)
    return (x - m) / torch.sqrt(v + eps)

def _scatter_add(tgt, idx, src, axis=0):
    return tgt.clone().index_add_(axis, idx, src)

def _segment_sum(src, seg, n):
    out = torch.zeros((n,) + src.shape[1:], dtype=src.dtype)
    return out.index_add_(0, seg, src)

def _pad(x, pw):
    flat = tuple((v for pair in reversed(pw) for v in pair))
    return torch.nn.functional.pad(x, flat)
kernel_name = 'concat_heads__memory_aug_recurrent_mem_tr__memory_aug_recurrent_mem_tr__prompt'

def setup_inputs():

    _w = lambda a: (lambda t: t.to(torch.bfloat16) if t.is_floating_point() else t)(torch.as_tensor(a))

    def _A_setup():
        B, S, Dm = (1, 2048, 640)
        H, Dh = (32, 128)
        M, seg = (8, 32)
        seg = min(seg, S)
        S = S // seg * seg
        return {'x': _w((lambda *s: torch.randn(*s, dtype=torch.bfloat16) * 0.05)(B, S, Dm)), 'mem0': _w((lambda *s: torch.randn(*s, dtype=torch.bfloat16) * 0.4)(B, M, Dm)), 'Wq': _w((lambda *s: torch.randn(*s, dtype=torch.bfloat16) * 6.4)(Dm, H, Dh) * Dm ** (-0.5)), 'Wk': _w((lambda *s: torch.randn(*s, dtype=torch.bfloat16) * 6.4)(Dm, H, Dh) * Dm ** (-0.5)), 'Wv': _w((lambda *s: torch.randn(*s, dtype=torch.bfloat16) * 0.4)(Dm, H, Dh) * Dm ** (-0.5)), 'Wo': _w((lambda *s: torch.randn(*s, dtype=torch.bfloat16) * 0.4)(H, Dh, Dm) * (H * Dh) ** (-0.5)), 'seg_len': seg}
    _A_in = _A_setup()

    def _B_setup():
        B, S, Dm = (1, 2048, 640)
        H, Dh = (32, 128)
        M, seg = (8, 32)
        seg = min(seg, S)
        S = S // seg * seg
        return {'x': _w((lambda *s: torch.randn(*s, dtype=torch.bfloat16) * 0.05)(B, S, Dm)), 'mem0': _w((lambda *s: torch.randn(*s, dtype=torch.bfloat16) * 0.4)(B, M, Dm)), 'Wq': _w((lambda *s: torch.randn(*s, dtype=torch.bfloat16) * 6.4)(Dm, H, Dh) * Dm ** (-0.5)), 'Wk': _w((lambda *s: torch.randn(*s, dtype=torch.bfloat16) * 6.4)(Dm, H, Dh) * Dm ** (-0.5)), 'Wv': _w((lambda *s: torch.randn(*s, dtype=torch.bfloat16) * 0.4)(Dm, H, Dh) * Dm ** (-0.5)), 'Wo': _w((lambda *s: torch.randn(*s, dtype=torch.bfloat16) * 0.4)(H, Dh, Dm) * (H * Dh) ** (-0.5)), 'seg_len': seg}
    _B_in = _B_setup()
    return {'A_x': _A_in['x'], 'A_mem0': _A_in['mem0'], 'A_Wq': _A_in['Wq'], 'A_Wk': _A_in['Wk'], 'A_Wv': _A_in['Wv'], 'A_Wo': _A_in['Wo'], 'A_seg_len': _A_in['seg_len'], 'B_x': _B_in['x'], 'B_mem0': _B_in['mem0'], 'B_Wq': _B_in['Wq'], 'B_Wk': _B_in['Wk'], 'B_Wv': _B_in['Wv'], 'B_Wo': _B_in['Wo'], 'B_seg_len': _B_in['seg_len']}

def reference(A_x, A_mem0, A_Wq, A_Wk, A_Wv, A_Wo, A_seg_len, B_x, B_mem0, B_Wq, B_Wk, B_Wv, B_Wo, B_seg_len):

    def _A_ref(x, mem0, Wq, Wk, Wv, Wo, seg_len):
        B, S, Dm = x.shape
        H, Dh = (Wq.shape[1], Wq.shape[2])
        M = mem0.shape[1]
        scale = Dh ** (-0.5)
        n_seg = S // seg_len
        L = M + seg_len
        idx = torch.arange(L)
        mask = (idx[:, None] < M) | (idx[:, None] >= idx[None, :])
        mem = mem0
        outs = []
        for s in range(n_seg):
            xs = x[:, s * seg_len:(s + 1) * seg_len, :].clone()
            h = torch.concatenate([mem, xs], axis=1)
            q = torch.einsum('btd,dhe->bhte', h, Wq)
            k = torch.einsum('btd,dhe->bhte', h, Wk)
            v = torch.einsum('btd,dhe->bhte', h, Wv)
            scores = torch.einsum('bhqe,bhke->bhqk', q, k) * scale
            scores = torch.where(mask[None, None], scores, -1000000000.0)
            p = _softmax(scores, axis=-1)
            o = torch.einsum('bhqk,bhke->bhqe', p, v)
            o = torch.einsum('bhte,hed->btd', o, Wo)
            mem = o[:, :M, :].clone()
            outs.append(o[:, M:, :])
        return torch.concatenate(outs, axis=1)

    def _B_ref(x, mem0, Wq, Wk, Wv, Wo, seg_len):
        B, S, Dm = x.shape
        H, Dh = (Wq.shape[1], Wq.shape[2])
        M = mem0.shape[1]
        scale = Dh ** (-0.5)
        n_seg = S // seg_len
        L = M + seg_len
        idx = torch.arange(L)
        mask = (idx[:, None] < M) | (idx[:, None] >= idx[None, :])
        mem = mem0
        outs = []
        for s in range(n_seg):
            xs = x[:, s * seg_len:(s + 1) * seg_len, :].clone()
            h = torch.concatenate([mem, xs], axis=1)
            q = torch.einsum('btd,dhe->bhte', h, Wq)
            k = torch.einsum('btd,dhe->bhte', h, Wk)
            v = torch.einsum('btd,dhe->bhte', h, Wv)
            scores = torch.einsum('bhqe,bhke->bhqk', q, k) * scale
            scores = torch.where(mask[None, None], scores, -1000000000.0)
            p = _softmax(scores, axis=-1)
            o = torch.einsum('bhqk,bhke->bhqe', p, v)
            o = torch.einsum('bhte,hed->btd', o, Wo)
            mem = o[:, :M, :].clone()
            outs.append(o[:, M:, :])
        return torch.concatenate(outs, axis=1)
    a = _A_ref(A_x, A_mem0, A_Wq, A_Wk, A_Wv, A_Wo, A_seg_len)
    b = _B_ref(B_x, B_mem0, B_Wq, B_Wk, B_Wv, B_Wo, B_seg_len)
    return torch.concatenate([a, b], axis=-1)
```

```asm
; @launch grid=(256,1,1) block=(256,1,1) lds=163840
.amdgcn_target "amdgcn-amd-amdhsa--gfx950"
.text
.globl concat_heads__memory_aug_recurrent_mem_tr__memory_aug_recurrent_mem_tr__prompt_kernel
.p2align 8
.type concat_heads__memory_aug_recurrent_mem_tr__memory_aug_recurrent_mem_tr__prompt_kernel,@function
concat_heads__memory_aug_recurrent_mem_tr__memory_aug_recurrent_mem_tr__prompt_kernel:
  s_cmp_ge_u32 s2, 256
  s_cbranch_scc1 Lexit
  s_load_dwordx16 s[64:79], s[0:1], 0
  s_load_dwordx16 s[80:95], s[0:1], 64
  s_load_dwordx2 s[96:97], s[0:1], 128
  s_getreg_b32 s3, hwreg(HW_REG_XCC_ID)
  s_and_b32 s3, s3, 7
  s_memrealtime s[98:99]
  s_waitcnt lgkmcnt(0)
  s_mov_b32 s4, s96
  s_and_b32 s5, s97, 0xffff
  s_mov_b32 s6, 268435456
  s_mov_b32 s7, 0x20000
  s_mov_b32 s28, s94
  s_and_b32 s29, s95, 0xffff
  s_mov_b32 s30, 256
  s_mov_b32 s31, 0x20000
  v_lshrrev_b32 v1, 6, v0
  s_nop 0
  v_readfirstlane_b32 s40, v1
  s_nop 3
  s_cmp_lg_u32 s40, 0
  s_cbranch_scc1 Lnoticket
  v_mov_b32 v2, 1
  v_mov_b32 v3, 0x40000000
  v_mov_b32 v4, 0
  v_cmp_eq_u32 vcc, 0, v0
  s_lshl_b32 s41, s3, 2
  s_nop 0
  v_cndmask_b32 v3, v3, v4, vcc
  buffer_atomic_add v2, v3, s[28:31], s41 offen sc0
  s_waitcnt vmcnt(0)
  v_readfirstlane_b32 s41, v2
  s_nop 3
  v_mov_b32 v2, s41
  ds_write_b32 v4, v2
  s_waitcnt lgkmcnt(0)
Lnoticket:
  s_barrier
  v_mov_b32 v4, 0
  ds_read_b32 v2, v4
  s_waitcnt lgkmcnt(0)
  v_readfirstlane_b32 s33, v2
  s_barrier
  s_nop 3
  s_cmp_ge_u32 s33, 32
  s_cbranch_scc1 Lexit
  s_and_b32 s32, s3, 1
  s_lshr_b32 s41, s3, 1
  s_cmp_eq_u32 s41, 1
  s_cbranch_scc1 Lrole_g1
  s_cmp_eq_u32 s41, 2
  s_cbranch_scc1 Lrole_g2
  s_cmp_eq_u32 s41, 3
  s_cbranch_scc1 Lrole_g3
  s_cmp_eq_u32 s32, 0
  s_cselect_b32 s8, s68, s82
  s_cselect_b32 s9, s69, s83
  s_cselect_b32 s12, s70, s84
  s_cselect_b32 s13, s71, s85
  s_cselect_b32 s16, s72, s86
  s_cselect_b32 s17, s73, s87
  s_cselect_b32 s20, s74, s88
  s_cselect_b32 s21, s75, s89
  s_cselect_b32 s24, s66, s80
  s_cselect_b32 s25, s67, s81
  s_and_b32 s9, s9, 0xffff
  s_mov_b32 s10, 5242880
  s_mov_b32 s11, 0x20000
  s_and_b32 s13, s13, 0xffff
  s_mov_b32 s14, 5242880
  s_mov_b32 s15, 0x20000
  s_and_b32 s17, s17, 0xffff
  s_mov_b32 s18, 5242880
  s_mov_b32 s19, 0x20000
  s_and_b32 s21, s21, 0xffff
  s_mov_b32 s22, 5242880
  s_mov_b32 s23, 0x20000
  s_and_b32 s25, s25, 0xffff
  s_mov_b32 s26, 10240
  s_mov_b32 s27, 0x20000
  s_mov_b32 s48, s92
  s_mov_b32 s49, s93
  s_mov_b32 s90, s98
  v_mov_b32 v27, v0
  v_lshrrev_b32 v8, 6, v0
  v_and_b32 v9, 63, v0
  v_readfirstlane_b32 s34, v8
  v_and_b32 v10, 15, v9
  v_lshrrev_b32 v11, 4, v9
  v_lshlrev_b32 v0, 4, v9
  v_lshrrev_b32 v12, 3, v9
  v_mul_u32_u24 v12, 10368, v12
  v_and_b32 v13, 7, v9
  v_lshl_add_u32 v1, v13, 4, v12
  v_lshrrev_b32 v12, 2, v10
  v_and_b32 v13, 1, v12
  v_lshrrev_b32 v12, 1, v12
  v_lshl_add_u32 v12, v11, 2, v12
  v_lshlrev_b32 v18, 3, v13
  v_xor_b32 v12, v12, v18
  v_and_b32 v18, 1, v10
  v_lshl_add_u32 v13, v13, 1, v18
  v_lshl_add_u32 v12, v13, 4, v12
  v_lshlrev_b32 v2, 3, v12
  v_lshrrev_b32 v12, 1, v11
  v_lshlrev_b32 v12, 3, v12
  v_xor_b32 v12, v12, v10
  v_lshl_add_u32 v12, v11, 4, v12
  v_lshlrev_b32 v12, 3, v12
  s_lshl_b32 s57, s34, 9
  v_add_u32 v3, s57, v12
  v_and_b32 v12, 7, v10
  v_lshrrev_b32 v13, 2, v12
  v_lshlrev_b32 v13, 1, v13
  v_xor_b32 v13, v13, v11
  v_lshlrev_b32 v13, 4, v13
  v_lshl_add_u32 v4, v12, 6, v13
  v_mov_b32 v12, 0xdddd
  v_mov_b32 v13, 0x8888
  v_cmp_gt_u32 vcc, 8, v10
  s_nop 1
  v_cndmask_b32 v5, v12, v13, vcc
  v_and_b32 v12, 7, v10
  v_lshlrev_b32 v13, 1, v12
  v_xor_b32 v13, v13, v11
  v_lshlrev_b32 v13, 4, v13
  v_lshl_add_u32 v13, v12, 8, v13
  v_add_u32 v6, 14336, v13
  s_lshl_b32 s57, s34, 11
  s_add_u32 s57, s57, 32768
  v_add_u32 v7, s57, v0
  v_lshlrev_b32 v12, 10, v11
  v_lshl_add_u32 v12, v10, 2, v12
  s_lshl_b32 s57, s34, 6
  s_add_u32 s57, s57, 32768
  v_add_u32 v14, s57, v12
  v_add_u32 v15, 0x10000, v14
  v_lshrrev_b32 v12, 1, v11
  v_and_b32 v13, 1, v11
  v_lshlrev_b32 v18, 4, v12
  v_lshl_add_u32 v18, v13, 1, v18
  v_lshlrev_b32 v18, 8, v18
  v_lshl_add_u32 v18, v10, 2, v18
  v_add_u32 v40, s57, v18
  v_add_u32 v41, 0x10000, v40
  v_xor_b32 v12, 1, v12
  v_lshlrev_b32 v18, 4, v12
  v_lshl_add_u32 v18, v13, 1, v18
  v_add_u32 v18, 1, v18
  v_lshlrev_b32 v18, 8, v18
  v_lshl_add_u32 v18, v10, 2, v18
  v_add_u32 v42, s57, v18
  v_add_u32 v43, 0x10000, v42
  v_lshlrev_b32 v12, 4, v10
  v_lshl_add_u32 v16, v11, 13, v12
  v_mul_u32_u24 v13, 1280, v11
  v_add_u32 v17, v13, v12
  s_mov_b32 s54, 0x3e028dc7
  s_mov_b32 s55, 0x20000
  s_mov_b32 s56, 0
  s_lshl_b32 s57, s32, 20
  s_add_u32 s52, s57, 1048576
  s_add_u32 s53, s52, 720896
  s_lshl_b32 s57, s32, 5
  s_add_u32 s57, s57, s33
  s_mul_i32 s51, s57, 81920
  s_add_u32 s51, s51, 4194304
  s_lshl_b32 s58, s34, 11
  s_add_u32 s51, s51, s58
  s_lshl_b32 s58, s57, 7
  s_add_u32 s62, s58, 0
  s_add_u32 s63, s58, 8192
  s_lshl_b32 s58, s34, 2
  s_add_u32 s63, s63, s58
  s_lshl_b32 s36, s33, 1
  s_add_u32 s36, s36, s34
  s_mov_b32 s37, 1
  s_cmp_lt_u32 s34, 2
  s_cbranch_scc1 Lch_jdone
  s_add_u32 s36, s33, 64
  s_cmp_eq_u32 s34, 2
  s_cselect_b32 s37, 1, 0
  s_cmp_lt_u32 s33, 16
  s_cselect_b32 s37, s37, 0
Lch_jdone:
  s_lshl_b32 s57, s32, 11
  s_add_u32 s57, s57, s33
  s_lshl_b32 s50, s57, 12
  s_add_u32 s50, s50, 16777216
  s_lshl_b32 s57, s57, 13
  s_lshl_b32 s58, s34, 11
  s_add_u32 s57, s57, s58
  s_add_u32 s48, s57, 33554432
  s_add_u32 s49, s57, 67108864
  s_mov_b32 s35, 0
  s_mov_b32 s60, 0
  s_mul_i32 s58, s33, 10368
  s_add_u32 s38, s52, s58
  s_add_u32 s39, s38, 4096
  s_add_u32 s40, s38, 8192
  s_lshl_b32 s58, s36, 7
  s_add_u32 s41, s52, s58
  s_add_u32 s42, s41, 82944
  s_add_u32 s43, s41, 165888
  s_add_u32 s44, s41, 248832
  s_add_u32 s80, s35, 1
  s_and_b32 s80, s80, 1
  s_lshl_b32 s58, s36, 7
  s_add_u32 s57, s35, 1
  s_and_b32 s57, s57, 3
  s_mul_i32 s57, s57, 10240
  s_add_u32 s57, s57, s53
  s_add_u32 s46, s57, s58
  s_lshl_b32 s59, s34, 11
  s_add_u32 s45, s57, s59
  s_add_u32 s57, s35, 3
  s_and_b32 s57, s57, 3
  s_mul_i32 s57, s57, 10240
  s_add_u32 s57, s57, s53
  s_add_u32 s47, s57, s58
  s_lshl_b32 s64, s33, 8
  s_lshl_b32 s57, s34, 16
  s_add_u32 s64, s64, s57
  s_mul_i32 s65, s33, 163840
  s_mul_i32 s57, s34, 10240
  s_add_u32 s65, s65, s57
  s_lshl_b32 s66, s34, 11
  s_add_u32 s57, s64, 0
  s_add_u32 m0, s66, 32768
  s_nop 0
  buffer_load_dwordx4 v16, s[8:11], s57 offen nt lds
  s_add_u32 s57, s64, 32768
  s_add_u32 m0, s66, 33792
  s_nop 0
  buffer_load_dwordx4 v16, s[8:11], s57 offen nt lds
  s_add_u32 s57, s64, 0
  s_add_u32 m0, s66, 40960
  s_nop 0
  buffer_load_dwordx4 v16, s[12:15], s57 offen nt lds
  s_add_u32 s57, s64, 32768
  s_add_u32 m0, s66, 41984
  s_nop 0
  buffer_load_dwordx4 v16, s[12:15], s57 offen nt lds
  s_add_u32 s57, s64, 4194304
  s_add_u32 m0, s66, 49152
  s_nop 0
  buffer_load_dwordx4 v16, s[16:19], s57 offen nt lds
  s_add_u32 s57, s64, 4227072
  s_add_u32 m0, s66, 50176
  s_nop 0
  buffer_load_dwordx4 v16, s[16:19], s57 offen nt lds
  s_add_u32 s57, s64, 4456448
  s_add_u32 m0, s66, 57344
  s_nop 0
  buffer_load_dwordx4 v16, s[16:19], s57 offen nt lds
  s_add_u32 s57, s64, 4489216
  s_add_u32 m0, s66, 58368
  s_nop 0
  buffer_load_dwordx4 v16, s[16:19], s57 offen nt lds
  s_add_u32 s57, s64, 4718592
  s_add_u32 m0, s66, 65536
  s_nop 0
  buffer_load_dwordx4 v16, s[16:19], s57 offen nt lds
  s_add_u32 s57, s64, 4751360
  s_add_u32 m0, s66, 66560
  s_nop 0
  buffer_load_dwordx4 v16, s[16:19], s57 offen nt lds
  s_add_u32 s57, s64, 4980736
  s_add_u32 m0, s66, 73728
  s_nop 0
  buffer_load_dwordx4 v16, s[16:19], s57 offen nt lds
  s_add_u32 s57, s64, 5013504
  s_add_u32 m0, s66, 74752
  s_nop 0
  buffer_load_dwordx4 v16, s[16:19], s57 offen nt lds
  s_add_u32 s57, s65, 82688
  s_add_u32 m0, s66, 81920
  s_nop 0
  buffer_load_dwordx4 v17, s[20:23], s57 offen nt lds
  s_add_u32 s57, s65, 87808
  s_add_u32 m0, s66, 82944
  s_nop 0
  buffer_load_dwordx4 v17, s[20:23], s57 offen nt lds
  s_add_u32 s57, s65, 1024
  s_add_u32 m0, s66, 90112
  s_nop 0
  buffer_load_dwordx4 v17, s[20:23], s57 offen nt lds
  s_add_u32 s57, s65, 6144
  s_add_u32 m0, s66, 91136
  s_nop 0
  buffer_load_dwordx4 v17, s[20:23], s57 offen nt lds
  s_add_u32 s57, s65, 41984
  s_add_u32 m0, s66, 98304
  s_nop 0
  buffer_load_dwordx4 v17, s[20:23], s57 offen nt lds
  s_add_u32 s57, s65, 47104
  s_add_u32 m0, s66, 99328
  s_nop 0
  buffer_load_dwordx4 v17, s[20:23], s57 offen nt lds
  s_add_u32 s57, s65, 82944
  s_add_u32 m0, s66, 106496
  s_nop 0
  buffer_load_dwordx4 v17, s[20:23], s57 offen nt lds
  s_add_u32 s57, s65, 88064
  s_add_u32 m0, s66, 107520
  s_nop 0
  buffer_load_dwordx4 v17, s[20:23], s57 offen nt lds
  s_add_u32 s57, s64, 0
  s_add_u32 m0, s66, 114688
  s_nop 0
  buffer_load_dwordx4 v16, s[16:19], s57 offen nt lds
  s_add_u32 s57, s64, 32768
  s_add_u32 m0, s66, 115712
  s_nop 0
  buffer_load_dwordx4 v16, s[16:19], s57 offen nt lds
  s_add_u32 s57, s64, 262144
  s_add_u32 m0, s66, 122880
  s_nop 0
  buffer_load_dwordx4 v16, s[8:11], s57 offen nt lds
  s_add_u32 s57, s64, 294912
  s_add_u32 m0, s66, 123904
  s_nop 0
  buffer_load_dwordx4 v16, s[8:11], s57 offen nt lds
  s_add_u32 s57, s64, 262144
  s_add_u32 m0, s66, 131072
  s_nop 0
  buffer_load_dwordx4 v16, s[12:15], s57 offen nt lds
  s_add_u32 s57, s64, 294912
  s_add_u32 m0, s66, 132096
  s_nop 0
  buffer_load_dwordx4 v16, s[12:15], s57 offen nt lds
  s_add_u32 s57, s64, 262144
  s_add_u32 m0, s66, 139264
  s_nop 0
  buffer_load_dwordx4 v16, s[16:19], s57 offen nt lds
  s_add_u32 s57, s64, 294912
  s_add_u32 m0, s66, 140288
  s_nop 0
  buffer_load_dwordx4 v16, s[16:19], s57 offen nt lds
  s_add_u32 s57, s64, 524288
  s_add_u32 m0, s66, 147456
  s_nop 0
  buffer_load_dwordx4 v16, s[8:11], s57 offen nt lds
  s_add_u32 s57, s64, 557056
  s_add_u32 m0, s66, 148480
  s_nop 0
  buffer_load_dwordx4 v16, s[8:11], s57 offen nt lds
  s_add_u32 s57, s64, 524288
  s_add_u32 m0, s66, 155648
  s_nop 0
  buffer_load_dwordx4 v16, s[12:15], s57 offen nt lds
  s_add_u32 s57, s64, 557056
  s_add_u32 m0, s66, 156672
  s_nop 0
  buffer_load_dwordx4 v16, s[12:15], s57 offen nt lds
  v_mov_b32 v20, 0
  v_mov_b32 v21, 0
  v_mov_b32 v22, 0
  v_mov_b32 v23, 0
  v_lshlrev_b32 v18, 4, v27
  buffer_store_dwordx4 v[20:23], v18, s[4:7], s38 offen
  buffer_store_dwordx4 v[20:23], v18, s[4:7], s39 offen
  v_cmp_gt_u32 vcc, 128, v27
  v_mov_b32 v19, 0x40000000
  s_nop 0
  v_cndmask_b32 v19, v19, v18, vcc
  buffer_store_dwordx4 v[20:23], v19, s[4:7], s40 offen
  v_mov_b32 v44, -1
  v_mov_b32 v45, -1
  v_mov_b32 v46, -1
  v_mov_b32 v47, -1
  s_mul_i32 s57, s33, 1280
  s_add_u32 s57, s57, s53
  v_cmp_gt_u32 vcc, 80, v27
  v_mov_b32 v19, 0x40000000
  s_nop 0
  v_cndmask_b32 v19, v19, v18, vcc
  buffer_store_dwordx4 v[44:47], v19, s[4:7], s57 offen
  v_mov_b32 v19, 0x40000000
  v_cmp_eq_u32 vcc, 0, v0
  s_nop 1
  v_cndmask_b32 v19, v19, v20, vcc
  buffer_store_dword v20, v19, s[4:7], s63 offen sc1
  v_and_b32 v9, 7, v27
  v_lshrrev_b32 v10, 3, v27
  v_lshrrev_b32 v11, 3, v10
  v_and_b32 v10, 7, v10
  v_lshrrev_b32 v12, 1, v10
  v_and_b32 v12, 1, v12
  v_and_b32 v13, 1, v10
  v_lshl_add_u32 v12, v13, 1, v12
  v_lshrrev_b32 v13, 2, v10
  v_lshl_add_u32 v12, v12, 1, v13
  v_and_b32 v13, 1, v11
  v_lshl_add_u32 v12, v13, 3, v12
  v_lshrrev_b32 v13, 1, v11
  v_lshlrev_b32 v8, 3, v13
  v_xor_b32 v12, v12, v8
  v_lshl_add_u32 v12, v12, 1, v13
  v_mul_u32_u24 v13, 1280, v9
  v_lshl_add_u32 v13, v12, 1, v13
  v_lshrrev_b32 v12, 2, v9
  v_lshlrev_b32 v12, 1, v12
  v_xor_b32 v12, v12, v11
  v_lshlrev_b32 v12, 4, v12
  v_lshl_add_u32 v12, v9, 6, v12
  v_lshl_add_u32 v12, v10, 1, v12
  buffer_load_ushort v44, v13, s[24:27], 0 offen offset:0
  buffer_load_ushort v45, v13, s[24:27], 0 offen offset:64
  buffer_load_ushort v46, v13, s[24:27], 0 offen offset:128
  buffer_load_ushort v47, v13, s[24:27], 0 offen offset:192
  buffer_load_ushort v48, v13, s[24:27], 0 offen offset:256
  buffer_load_ushort v49, v13, s[24:27], 0 offen offset:320
  buffer_load_ushort v50, v13, s[24:27], 0 offen offset:384
  buffer_load_ushort v51, v13, s[24:27], 0 offen offset:448
  buffer_load_ushort v52, v13, s[24:27], 0 offen offset:512
  buffer_load_ushort v53, v13, s[24:27], 0 offen offset:576
  buffer_load_ushort v54, v13, s[24:27], 0 offen offset:640
  buffer_load_ushort v55, v13, s[24:27], 0 offen offset:704
  buffer_load_ushort v56, v13, s[24:27], 0 offen offset:768
  buffer_load_ushort v57, v13, s[24:27], 0 offen offset:832
  buffer_load_ushort v58, v13, s[24:27], 0 offen offset:896
  buffer_load_ushort v59, v13, s[24:27], 0 offen offset:960
  buffer_load_ushort v60, v13, s[24:27], 0 offen offset:1024
  buffer_load_ushort v61, v13, s[24:27], 0 offen offset:1088
  buffer_load_ushort v62, v13, s[24:27], 0 offen offset:1152
  buffer_load_ushort v63, v13, s[24:27], 0 offen offset:1216
  s_waitcnt vmcnt(55)
  s_barrier
  ds_read2st64_b32 v[24:25], v40 offset0:0 offset1:8
  ds_read2st64_b32 v[26:27], v40 offset0:4 offset1:12
  ds_read2st64_b32 v[28:29], v42 offset0:0 offset1:8
  ds_read2st64_b32 v[30:31], v42 offset0:4 offset1:12
  s_waitcnt lgkmcnt(0)
  s_add_u32 s57, s51, 0
  buffer_store_dwordx4 v[24:27], v0, s[4:7], s57 offen
  buffer_store_dwordx4 v[28:31], v0, s[4:7], s57 offen offset:1024
  s_waitcnt vmcnt(55)
  s_barrier
  s_add_u32 s57, s64, 524288
  s_add_u32 m0, s66, 32768
  s_nop 0
  buffer_load_dwordx4 v16, s[16:19], s57 offen nt lds
  s_add_u32 s57, s64, 557056
  s_add_u32 m0, s66, 33792
  s_nop 0
  buffer_load_dwordx4 v16, s[16:19], s57 offen nt lds
  ds_read2st64_b32 v[32:33], v40 offset0:32 offset1:40
  ds_read2st64_b32 v[34:35], v40 offset0:36 offset1:44
  ds_read2st64_b32 v[36:37], v42 offset0:32 offset1:40
  ds_read2st64_b32 v[38:39], v42 offset0:36 offset1:44
  s_waitcnt lgkmcnt(0)
  s_add_u32 s57, s51, 8192
  buffer_store_dwordx4 v[32:35], v0, s[4:7], s57 offen
  buffer_store_dwordx4 v[36:39], v0, s[4:7], s57 offen offset:1024
  s_waitcnt vmcnt(57)
  s_barrier
  s_add_u32 s57, s64, 786432
  s_add_u32 m0, s66, 40960
  s_nop 0
  buffer_load_dwordx4 v16, s[12:15], s57 offen nt lds
  s_add_u32 s57, s64, 819200
  s_add_u32 m0, s66, 41984
  s_nop 0
  buffer_load_dwordx4 v16, s[12:15], s57 offen nt lds
  ds_read2st64_b32 v[24:25], v40 offset0:64 offset1:72
  ds_read2st64_b32 v[26:27], v40 offset0:68 offset1:76
  ds_read2st64_b32 v[28:29], v42 offset0:64 offset1:72
  ds_read2st64_b32 v[30:31], v42 offset0:68 offset1:76
  s_waitcnt lgkmcnt(0)
  s_add_u32 s57, s51, 16384
  buffer_store_dwordx4 v[24:27], v0, s[4:7], s57 offen
  buffer_store_dwordx4 v[28:31], v0, s[4:7], s57 offen offset:1024
  s_waitcnt vmcnt(59)
  s_barrier
  s_add_u32 s57, s64, 786432
  s_add_u32 m0, s66, 49152
  s_nop 0
  buffer_load_dwordx4 v16, s[16:19], s57 offen nt lds
  s_add_u32 s57, s64, 819200
  s_add_u32 m0, s66, 50176
  s_nop 0
  buffer_load_dwordx4 v16, s[16:19], s57 offen nt lds
  ds_read2st64_b32 v[32:33], v40 offset0:96 offset1:104
  ds_read2st64_b32 v[34:35], v40 offset0:100 offset1:108
  ds_read2st64_b32 v[36:37], v42 offset0:96 offset1:104
  ds_read2st64_b32 v[38:39], v42 offset0:100 offset1:108
  s_waitcnt lgkmcnt(0)
  s_add_u32 s57, s51, 24576
  buffer_store_dwordx4 v[32:35], v0, s[4:7], s57 offen
  buffer_store_dwordx4 v[36:39], v0, s[4:7], s57 offen offset:1024
  s_waitcnt vmcnt(61)
  s_barrier
  s_add_u32 s57, s64, 1048576
  s_add_u32 m0, s66, 57344
  s_nop 0
  buffer_load_dwordx4 v16, s[8:11], s57 offen nt lds
  s_add_u32 s57, s64, 1081344
  s_add_u32 m0, s66, 58368
  s_nop 0
  buffer_load_dwordx4 v16, s[8:11], s57 offen nt lds
  ds_read2st64_b32 v[24:25], v40 offset0:128 offset1:136
  ds_read2st64_b32 v[26:27], v40 offset0:132 offset1:140
  ds_read2st64_b32 v[28:29], v42 offset0:128 offset1:136
  ds_read2st64_b32 v[30:31], v42 offset0:132 offset1:140
  s_waitcnt lgkmcnt(0)
  s_add_u32 s57, s51, 32768
  buffer_store_dwordx4 v[24:27], v0, s[4:7], s57 offen
  buffer_store_dwordx4 v[28:31], v0, s[4:7], s57 offen offset:1024
  s_waitcnt vmcnt(63)
  s_barrier
  s_add_u32 s57, s64, 1048576
  s_add_u32 m0, s66, 65536
  s_nop 0
  buffer_load_dwordx4 v16, s[16:19], s57 offen nt lds
  s_add_u32 s57, s64, 1081344
  s_add_u32 m0, s66, 66560
  s_nop 0
  buffer_load_dwordx4 v16, s[16:19], s57 offen nt lds
  ds_read2st64_b32 v[32:33], v40 offset0:160 offset1:168
  ds_read2st64_b32 v[34:35], v40 offset0:164 offset1:172
  ds_read2st64_b32 v[36:37], v42 offset0:160 offset1:168
  ds_read2st64_b32 v[38:39], v42 offset0:164 offset1:172
  s_waitcnt lgkmcnt(0)
  s_add_u32 s57, s51, 40960
  buffer_store_dwordx4 v[32:35], v0, s[4:7], s57 offen
  buffer_store_dwordx4 v[36:39], v0, s[4:7], s57 offen offset:1024
  s_waitcnt vmcnt(63)
  s_barrier
  s_add_u32 s57, s64, 1310720
  s_add_u32 m0, s66, 73728
  s_nop 0
  buffer_load_dwordx4 v16, s[8:11], s57 offen nt lds
  s_add_u32 s57, s64, 1343488
  s_add_u32 m0, s66, 74752
  s_nop 0
  buffer_load_dwordx4 v16, s[8:11], s57 offen nt lds
  ds_read2st64_b32 v[24:25], v14 offset0:192 offset1:193
  ds_read2st64_b32 v[26:27], v14 offset0:194 offset1:195
  ds_read2st64_b32 v[28:29], v14 offset0:208 offset1:209
  ds_read2st64_b32 v[30:31], v14 offset0:210 offset1:211
  s_waitcnt lgkmcnt(0)
  s_add_u32 s57, s51, 73728
  buffer_store_dwordx4 v[24:27], v0, s[4:7], s57 offen
  buffer_store_dwordx4 v[28:31], v0, s[4:7], s57 offen offset:1024
  s_barrier
  s_add_u32 s57, s64, 1310720
  s_add_u32 m0, s66, 81920
  s_nop 0
  buffer_load_dwordx4 v16, s[12:15], s57 offen nt lds
  s_add_u32 s57, s64, 1343488
  s_add_u32 m0, s66, 82944
  s_nop 0
  buffer_load_dwordx4 v16, s[12:15], s57 offen nt lds
  ds_read2st64_b32 v[32:33], v14 offset0:224 offset1:225
  ds_read2st64_b32 v[34:35], v14 offset0:226 offset1:227
  ds_read2st64_b32 v[36:37], v14 offset0:240 offset1:241
  ds_read2st64_b32 v[38:39], v14 offset0:242 offset1:243
  s_waitcnt lgkmcnt(0)
  s_add_u32 s57, s51, 49152
  buffer_store_dwordx4 v[32:35], v0, s[4:7], s57 offen
  buffer_store_dwordx4 v[36:39], v0, s[4:7], s57 offen offset:1024
  s_waitcnt vmcnt(63)
  s_barrier
  s_add_u32 s57, s64, 1310720
  s_add_u32 m0, s66, 90112
  s_nop 0
  buffer_load_dwordx4 v16, s[16:19], s57 offen nt lds
  s_add_u32 s57, s64, 1343488
  s_add_u32 m0, s66, 91136
  s_nop 0
  buffer_load_dwordx4 v16, s[16:19], s57 offen nt lds
  ds_read2st64_b32 v[24:25], v15 offset0:0 offset1:1
  ds_read2st64_b32 v[26:27], v15 offset0:2 offset1:3
  ds_read2st64_b32 v[28:29], v15 offset0:16 offset1:17
  ds_read2st64_b32 v[30:31], v15 offset0:18 offset1:19
  s_waitcnt lgkmcnt(0)
  s_add_u32 s57, s51, 57344
  buffer_store_dwordx4 v[24:27], v0, s[4:7], s57 offen
  buffer_store_dwordx4 v[28:31], v0, s[4:7], s57 offen offset:1024
  s_barrier
  s_add_u32 s57, s64, 1572864
  s_add_u32 m0, s66, 98304
  s_nop 0
  buffer_load_dwordx4 v16, s[12:15], s57 offen nt lds
  s_add_u32 s57, s64, 1605632
  s_add_u32 m0, s66, 99328
  s_nop 0
  buffer_load_dwordx4 v16, s[12:15], s57 offen nt lds
  ds_read2st64_b32 v[32:33], v15 offset0:32 offset1:33
  ds_read2st64_b32 v[34:35], v15 offset0:34 offset1:35
  ds_read2st64_b32 v[36:37], v15 offset0:48 offset1:49
  ds_read2st64_b32 v[38:39], v15 offset0:50 offset1:51
  s_waitcnt lgkmcnt(0)
  s_add_u32 s57, s51, 65536
  buffer_store_dwordx4 v[32:35], v0, s[4:7], s57 offen
  buffer_store_dwordx4 v[36:39], v0, s[4:7], s57 offen offset:1024
  s_barrier
  s_add_u32 s57, s64, 1572864
  s_add_u32 m0, s66, 106496
  s_nop 0
  buffer_load_dwordx4 v16, s[16:19], s57 offen nt lds
  s_add_u32 s57, s64, 1605632
  s_add_u32 m0, s66, 107520
  s_nop 0
  buffer_load_dwordx4 v16, s[16:19], s57 offen nt lds
  ds_read2st64_b32 v[80:81], v41 offset0:64 offset1:72
  ds_read2st64_b32 v[82:83], v41 offset0:68 offset1:76
  ds_read2st64_b32 v[84:85], v43 offset0:64 offset1:72
  ds_read2st64_b32 v[86:87], v43 offset0:68 offset1:76
  s_waitcnt lgkmcnt(0)
  s_barrier
  s_add_u32 s57, s64, 1835008
  s_add_u32 m0, s66, 114688
  s_nop 0
  buffer_load_dwordx4 v16, s[8:11], s57 offen nt lds
  s_add_u32 s57, s64, 1867776
  s_add_u32 m0, s66, 115712
  s_nop 0
  buffer_load_dwordx4 v16, s[8:11], s57 offen nt lds
  ds_read2st64_b32 v[88:89], v41 offset0:96 offset1:104
  ds_read2st64_b32 v[90:91], v41 offset0:100 offset1:108
  ds_read2st64_b32 v[92:93], v43 offset0:96 offset1:104
  ds_read2st64_b32 v[94:95], v43 offset0:100 offset1:108
  s_waitcnt lgkmcnt(0)
  s_waitcnt vmcnt(63)
  s_barrier
  s_add_u32 s57, s64, 1835008
  s_add_u32 m0, s66, 122880
  s_nop 0
  buffer_load_dwordx4 v16, s[12:15], s57 offen nt lds
  s_add_u32 s57, s64, 1867776
  s_add_u32 m0, s66, 123904
  s_nop 0
  buffer_load_dwordx4 v16, s[12:15], s57 offen nt lds
  ds_read2st64_b32 v[96:97], v41 offset0:128 offset1:136
  ds_read2st64_b32 v[98:99], v41 offset0:132 offset1:140
  ds_read2st64_b32 v[100:101], v43 offset0:128 offset1:136
  ds_read2st64_b32 v[102:103], v43 offset0:132 offset1:140
  s_waitcnt lgkmcnt(0)
  s_barrier
  s_add_u32 s57, s64, 1835008
  s_add_u32 m0, s66, 131072
  s_nop 0
  buffer_load_dwordx4 v16, s[16:19], s57 offen nt lds
  s_add_u32 s57, s64, 1867776
  s_add_u32 m0, s66, 132096
  s_nop 0
  buffer_load_dwordx4 v16, s[16:19], s57 offen nt lds
  ds_read2st64_b32 v[104:105], v41 offset0:160 offset1:168
  ds_read2st64_b32 v[106:107], v41 offset0:164 offset1:172
  ds_read2st64_b32 v[108:109], v43 offset0:160 offset1:168
  ds_read2st64_b32 v[110:111], v43 offset0:164 offset1:172
  s_waitcnt lgkmcnt(0)
  s_barrier
  s_add_u32 s57, s64, 2097152
  s_add_u32 m0, s66, 139264
  s_nop 0
  buffer_load_dwordx4 v16, s[8:11], s57 offen nt lds
  s_add_u32 s57, s64, 2129920
  s_add_u32 m0, s66, 140288
  s_nop 0
  buffer_load_dwordx4 v16, s[8:11], s57 offen nt lds
  ds_read2st64_b32 v[112:113], v41 offset0:192 offset1:200
  ds_read2st64_b32 v[114:115], v41 offset0:196 offset1:204
  ds_read2st64_b32 v[116:117], v43 offset0:192 offset1:200
  ds_read2st64_b32 v[118:119], v43 offset0:196 offset1:204
  s_waitcnt lgkmcnt(0)
  s_barrier
  s_add_u32 s57, s64, 2097152
  s_add_u32 m0, s66, 147456
  s_nop 0
  buffer_load_dwordx4 v16, s[16:19], s57 offen nt lds
  s_add_u32 s57, s64, 2129920
  s_add_u32 m0, s66, 148480
  s_nop 0
  buffer_load_dwordx4 v16, s[16:19], s57 offen nt lds
  ds_read2st64_b32 v[120:121], v41 offset0:224 offset1:232
  ds_read2st64_b32 v[122:123], v41 offset0:228 offset1:236
  ds_read2st64_b32 v[124:125], v43 offset0:224 offset1:232
  ds_read2st64_b32 v[126:127], v43 offset0:228 offset1:236
  s_waitcnt lgkmcnt(0)
  s_waitcnt vmcnt(46)
  s_barrier
  s_cmp_lg_u32 s34, 0
  s_cbranch_scc1 Lch_noarr
  v_mov_b32 v20, 1
  buffer_atomic_add v20, v19, s[28:31], 0 offen offset:64
Lch_noarr:
  ds_write_b16 v12, v44 offset:0
  ds_write_b16 v12, v45 offset:512
  ds_write_b16 v12, v46 offset:1024
  ds_write_b16 v12, v47 offset:1536
  ds_write_b16 v12, v48 offset:2048
  ds_write_b16 v12, v49 offset:2560
  ds_write_b16 v12, v50 offset:3072
  ds_write_b16 v12, v51 offset:3584
  ds_write_b16 v12, v52 offset:4096
  ds_write_b16 v12, v53 offset:4608
  ds_write_b16 v12, v54 offset:5120
  ds_write_b16 v12, v55 offset:5632
  ds_write_b16 v12, v56 offset:6144
  ds_write_b16 v12, v57 offset:6656
  ds_write_b16 v12, v58 offset:7168
  ds_write_b16 v12, v59 offset:7680
  ds_write_b16 v12, v60 offset:8192
  ds_write_b16 v12, v61 offset:8704
  ds_write_b16 v12, v62 offset:9216
  ds_write_b16 v12, v63 offset:9728
  s_add_u32 s57, s64, 2359296
  s_add_u32 m0, s66, 155648
  s_nop 0
  buffer_load_dwordx4 v16, s[12:15], s57 offen nt lds
  s_add_u32 s57, s64, 2392064
  s_add_u32 m0, s66, 156672
  s_nop 0
  buffer_load_dwordx4 v16, s[12:15], s57 offen nt lds
  ds_read2st64_b32 v[128:129], v40 offset0:0 offset1:8
  ds_read2st64_b32 v[130:131], v40 offset0:4 offset1:12
  ds_read2st64_b32 v[132:133], v42 offset0:0 offset1:8
  ds_read2st64_b32 v[134:135], v42 offset0:4 offset1:12
  s_waitcnt lgkmcnt(0)
  s_waitcnt vmcnt(44)
  s_barrier
  s_add_u32 s57, s64, 2359296
  s_add_u32 m0, s66, 32768
  s_nop 0
  buffer_load_dwordx4 v16, s[16:19], s57 offen nt lds
  s_add_u32 s57, s64, 2392064
  s_add_u32 m0, s66, 33792
  s_nop 0
  buffer_load_dwordx4 v16, s[16:19], s57 offen nt lds
  ds_read2st64_b32 v[136:137], v40 offset0:32 offset1:40
  ds_read2st64_b32 v[138:139], v40 offset0:36 offset1:44
  ds_read2st64_b32 v[140:141], v42 offset0:32 offset1:40
  ds_read2st64_b32 v[142:143], v42 offset0:36 offset1:44
  s_waitcnt lgkmcnt(0)
  s_waitcnt vmcnt(42)
  s_barrier
  s_add_u32 s57, s64, 2621440
  s_add_u32 m0, s66, 40960
  s_nop 0
  buffer_load_dwordx4 v16, s[8:11], s57 offen nt lds
  s_add_u32 s57, s64, 2654208
  s_add_u32 m0, s66, 41984
  s_nop 0
  buffer_load_dwordx4 v16, s[8:11], s57 offen nt lds
  ds_read2st64_b32 v[144:145], v40 offset0:64 offset1:72
  ds_read2st64_b32 v[146:147], v40 offset0:68 offset1:76
  ds_read2st64_b32 v[148:149], v42 offset0:64 offset1:72
  ds_read2st64_b32 v[150:151], v42 offset0:68 offset1:76
  s_waitcnt lgkmcnt(0)
  s_waitcnt vmcnt(40)
  s_barrier
  s_add_u32 s57, s64, 2621440
  s_add_u32 m0, s66, 49152
  s_nop 0
  buffer_load_dwordx4 v16, s[12:15], s57 offen nt lds
  s_add_u32 s57, s64, 2654208
  s_add_u32 m0, s66, 50176
  s_nop 0
  buffer_load_dwordx4 v16, s[12:15], s57 offen nt lds
  ds_read2st64_b32 v[152:153], v40 offset0:96 offset1:104
  ds_read2st64_b32 v[154:155], v40 offset0:100 offset1:108
  ds_read2st64_b32 v[156:157], v42 offset0:96 offset1:104
  ds_read2st64_b32 v[158:159], v42 offset0:100 offset1:108
  s_waitcnt lgkmcnt(0)
  s_waitcnt vmcnt(38)
  s_barrier
  s_add_u32 s57, s64, 2621440
  s_add_u32 m0, s66, 57344
  s_nop 0
  buffer_load_dwordx4 v16, s[16:19], s57 offen nt lds
  s_add_u32 s57, s64, 2654208
  s_add_u32 m0, s66, 58368
  s_nop 0
  buffer_load_dwordx4 v16, s[16:19], s57 offen nt lds
  ds_read2st64_b32 v[160:161], v40 offset0:128 offset1:136
  ds_read2st64_b32 v[162:163], v40 offset0:132 offset1:140
  ds_read2st64_b32 v[164:165], v42 offset0:128 offset1:136
  ds_read2st64_b32 v[166:167], v42 offset0:132 offset1:140
  s_waitcnt lgkmcnt(0)
  s_waitcnt vmcnt(36)
  s_barrier
  s_add_u32 s57, s64, 2883584
  s_add_u32 m0, s66, 65536
  s_nop 0
  buffer_load_dwordx4 v16, s[8:11], s57 offen nt lds
  s_add_u32 s57, s64, 2916352
  s_add_u32 m0, s66, 66560
  s_nop 0
  buffer_load_dwordx4 v16, s[8:11], s57 offen nt lds
  ds_read2st64_b32 v[168:169], v40 offset0:160 offset1:168
  ds_read2st64_b32 v[170:171], v40 offset0:164 offset1:172
  ds_read2st64_b32 v[172:173], v42 offset0:160 offset1:168
  ds_read2st64_b32 v[174:175], v42 offset0:164 offset1:172
  s_waitcnt lgkmcnt(0)
  s_waitcnt vmcnt(34)
  s_barrier
  s_add_u32 s57, s64, 2883584
  s_add_u32 m0, s66, 73728
  s_nop 0
  buffer_load_dwordx4 v16, s[16:19], s57 offen nt lds
  s_add_u32 s57, s64, 2916352
  s_add_u32 m0, s66, 74752
  s_nop 0
  buffer_load_dwordx4 v16, s[16:19], s57 offen nt lds
  ds_read2st64_b32 v[176:177], v40 offset0:192 offset1:200
  ds_read2st64_b32 v[178:179], v40 offset0:196 offset1:204
  ds_read2st64_b32 v[180:181], v42 offset0:192 offset1:200
  ds_read2st64_b32 v[182:183], v42 offset0:196 offset1:204
  s_waitcnt lgkmcnt(0)
  s_waitcnt vmcnt(32)
  s_barrier
  s_add_u32 s57, s64, 3145728
  s_add_u32 m0, s66, 81920
  s_nop 0
  buffer_load_dwordx4 v16, s[8:11], s57 offen nt lds
  s_add_u32 s57, s64, 3178496
  s_add_u32 m0, s66, 82944
  s_nop 0
  buffer_load_dwordx4 v16, s[8:11], s57 offen nt lds
  ds_read2st64_b32 v[184:185], v40 offset0:224 offset1:232
  ds_read2st64_b32 v[186:187], v40 offset0:228 offset1:236
  ds_read2st64_b32 v[188:189], v42 offset0:224 offset1:232
  ds_read2st64_b32 v[190:191], v42 offset0:228 offset1:236
  s_waitcnt lgkmcnt(0)
  s_waitcnt vmcnt(30)
  s_barrier
  s_add_u32 s57, s64, 3145728
  s_add_u32 m0, s66, 90112
  s_nop 0
  buffer_load_dwordx4 v16, s[12:15], s57 offen nt lds
  s_add_u32 s57, s64, 3178496
  s_add_u32 m0, s66, 91136
  s_nop 0
  buffer_load_dwordx4 v16, s[12:15], s57 offen nt lds
  ds_read2st64_b32 v[192:193], v41 offset0:0 offset1:8
  ds_read2st64_b32 v[194:195], v41 offset0:4 offset1:12
  ds_read2st64_b32 v[196:197], v43 offset0:0 offset1:8
  ds_read2st64_b32 v[198:199], v43 offset0:4 offset1:12
  s_waitcnt lgkmcnt(0)
  s_waitcnt vmcnt(28)
  s_barrier
  s_add_u32 s57, s64, 3145728
  s_add_u32 m0, s66, 98304
  s_nop 0
  buffer_load_dwordx4 v16, s[16:19], s57 offen nt lds
  s_add_u32 s57, s64, 3178496
  s_add_u32 m0, s66, 99328
  s_nop 0
  buffer_load_dwordx4 v16, s[16:19], s57 offen nt lds
  ds_read2st64_b32 v[200:201], v41 offset0:32 offset1:40
  ds_read2st64_b32 v[202:203], v41 offset0:36 offset1:44
  ds_read2st64_b32 v[204:205], v43 offset0:32 offset1:40
  ds_read2st64_b32 v[206:207], v43 offset0:36 offset1:44
  s_waitcnt lgkmcnt(0)
  s_waitcnt vmcnt(28)
  s_barrier
  s_add_u32 s57, s64, 3407872
  s_add_u32 m0, s66, 106496
  s_nop 0
  buffer_load_dwordx4 v16, s[12:15], s57 offen nt lds
  s_add_u32 s57, s64, 3440640
  s_add_u32 m0, s66, 107520
  s_nop 0
  buffer_load_dwordx4 v16, s[12:15], s57 offen nt lds
  ds_read2st64_b32 v[208:209], v41 offset0:64 offset1:72
  ds_read2st64_b32 v[210:211], v41 offset0:68 offset1:76
  ds_read2st64_b32 v[212:213], v43 offset0:64 offset1:72
  ds_read2st64_b32 v[214:215], v43 offset0:68 offset1:76
  s_waitcnt lgkmcnt(0)
  s_waitcnt vmcnt(28)
  s_barrier
  s_add_u32 s57, s64, 3407872
  s_add_u32 m0, s66, 114688
  s_nop 0
  buffer_load_dwordx4 v16, s[16:19], s57 offen nt lds
  s_add_u32 s57, s64, 3440640
  s_add_u32 m0, s66, 115712
  s_nop 0
  buffer_load_dwordx4 v16, s[16:19], s57 offen nt lds
  ds_read2st64_b32 v[216:217], v41 offset0:96 offset1:104
  ds_read2st64_b32 v[218:219], v41 offset0:100 offset1:108
  ds_read2st64_b32 v[220:221], v43 offset0:96 offset1:104
  ds_read2st64_b32 v[222:223], v43 offset0:100 offset1:108
  s_waitcnt lgkmcnt(0)
  s_waitcnt vmcnt(28)
  s_barrier
  s_add_u32 s57, s64, 3670016
  s_add_u32 m0, s66, 122880
  s_nop 0
  buffer_load_dwordx4 v16, s[8:11], s57 offen nt lds
  s_add_u32 s57, s64, 3702784
  s_add_u32 m0, s66, 123904
  s_nop 0
  buffer_load_dwordx4 v16, s[8:11], s57 offen nt lds
  ds_read2st64_b32 v[224:225], v41 offset0:128 offset1:136
  ds_read2st64_b32 v[226:227], v41 offset0:132 offset1:140
  ds_read2st64_b32 v[228:229], v43 offset0:128 offset1:136
  ds_read2st64_b32 v[230:231], v43 offset0:132 offset1:140
  s_waitcnt lgkmcnt(0)
  s_waitcnt vmcnt(28)
  s_barrier
  s_add_u32 s57, s64, 3670016
  s_add_u32 m0, s66, 131072
  s_nop 0
  buffer_load_dwordx4 v16, s[16:19], s57 offen nt lds
  s_add_u32 s57, s64, 3702784
  s_add_u32 m0, s66, 132096
  s_nop 0
  buffer_load_dwordx4 v16, s[16:19], s57 offen nt lds
  ds_read2st64_b32 v[232:233], v41 offset0:160 offset1:168
  ds_read2st64_b32 v[234:235], v41 offset0:164 offset1:172
  ds_read2st64_b32 v[236:237], v43 offset0:160 offset1:168
  ds_read2st64_b32 v[238:239], v43 offset0:164 offset1:172
  s_waitcnt lgkmcnt(0)
  s_waitcnt vmcnt(28)
  s_barrier
  s_add_u32 s57, s64, 3932160
  s_add_u32 m0, s66, 139264
  s_nop 0
  buffer_load_dwordx4 v16, s[8:11], s57 offen nt lds
  s_add_u32 s57, s64, 3964928
  s_add_u32 m0, s66, 140288
  s_nop 0
  buffer_load_dwordx4 v16, s[8:11], s57 offen nt lds
  ds_read2st64_b32 v[240:241], v41 offset0:192 offset1:200
  ds_read2st64_b32 v[242:243], v41 offset0:196 offset1:204
  ds_read2st64_b32 v[244:245], v43 offset0:192 offset1:200
  ds_read2st64_b32 v[246:247], v43 offset0:196 offset1:204
  s_waitcnt lgkmcnt(0)
  s_waitcnt vmcnt(28)
  s_barrier
  s_add_u32 s57, s64, 3932160
  s_add_u32 m0, s66, 147456
  s_nop 0
  buffer_load_dwordx4 v16, s[12:15], s57 offen nt lds
  s_add_u32 s57, s64, 3964928
  s_add_u32 m0, s66, 148480
  s_nop 0
  buffer_load_dwordx4 v16, s[12:15], s57 offen nt lds
  ds_read2st64_b32 v[248:249], v41 offset0:224 offset1:232
  ds_read2st64_b32 v[250:251], v41 offset0:228 offset1:236
  ds_read2st64_b32 v[252:253], v43 offset0:224 offset1:232
  ds_read2st64_b32 v[254:255], v43 offset0:228 offset1:236
  s_waitcnt lgkmcnt(0)
  s_waitcnt vmcnt(28)
  s_barrier
  s_add_u32 s57, s64, 3932160
  s_add_u32 m0, s66, 155648
  s_nop 0
  buffer_load_dwordx4 v16, s[16:19], s57 offen nt lds
  s_add_u32 s57, s64, 3964928
  s_add_u32 m0, s66, 156672
  s_nop 0
  buffer_load_dwordx4 v16, s[16:19], s57 offen nt lds
  ds_read2st64_b32 a[0:1], v40 offset0:0 offset1:8
  ds_read2st64_b32 a[2:3], v40 offset0:4 offset1:12
  ds_read2st64_b32 a[4:5], v42 offset0:0 offset1:8
  ds_read2st64_b32 a[6:7], v42 offset0:4 offset1:12
  s_waitcnt lgkmcnt(0)
  s_waitcnt vmcnt(28)
  s_barrier
  s_add_u32 s57, s64, 4194304
  s_add_u32 m0, s66, 32768
  s_nop 0
  buffer_load_dwordx4 v16, s[12:15], s57 offen nt lds
  s_add_u32 s57, s64, 4227072
  s_add_u32 m0, s66, 33792
  s_nop 0
  buffer_load_dwordx4 v16, s[12:15], s57 offen nt lds
  ds_read2st64_b32 a[8:9], v40 offset0:32 offset1:40
  ds_read2st64_b32 a[10:11], v40 offset0:36 offset1:44
  ds_read2st64_b32 a[12:13], v42 offset0:32 offset1:40
  ds_read2st64_b32 a[14:15], v42 offset0:36 offset1:44
  s_waitcnt lgkmcnt(0)
  s_waitcnt vmcnt(28)
  s_barrier
  s_add_u32 s57, s64, 4456448
  s_add_u32 m0, s66, 40960
  s_nop 0
  buffer_load_dwordx4 v16, s[8:11], s57 offen nt lds
  s_add_u32 s57, s64, 4489216
  s_add_u32 m0, s66, 41984
  s_nop 0
  buffer_load_dwordx4 v16, s[8:11], s57 offen nt lds
  ds_read2st64_b32 a[16:17], v40 offset0:64 offset1:72
  ds_read2st64_b32 a[18:19], v40 offset0:68 offset1:76
  ds_read2st64_b32 a[20:21], v42 offset0:64 offset1:72
  ds_read2st64_b32 a[22:23], v42 offset0:68 offset1:76
  s_waitcnt lgkmcnt(0)
  s_waitcnt vmcnt(28)
  s_barrier
  s_add_u32 s57, s64, 4718592
  s_add_u32 m0, s66, 49152
  s_nop 0
  buffer_load_dwordx4 v16, s[8:11], s57 offen nt lds
  s_add_u32 s57, s64, 4751360
  s_add_u32 m0, s66, 50176
  s_nop 0
  buffer_load_dwordx4 v16, s[8:11], s57 offen nt lds
  ds_read2st64_b32 a[24:25], v40 offset0:96 offset1:104
  ds_read2st64_b32 a[26:27], v40 offset0:100 offset1:108
  ds_read2st64_b32 a[28:29], v42 offset0:96 offset1:104
  ds_read2st64_b32 a[30:31], v42 offset0:100 offset1:108
  s_waitcnt lgkmcnt(0)
  s_waitcnt vmcnt(28)
  s_barrier
  s_add_u32 s57, s64, 4718592
  s_add_u32 m0, s66, 57344
  s_nop 0
  buffer_load_dwordx4 v16, s[12:15], s57 offen nt lds
  s_add_u32 s57, s64, 4751360
  s_add_u32 m0, s66, 58368
  s_nop 0
  buffer_load_dwordx4 v16, s[12:15], s57 offen nt lds
  ds_read2st64_b32 a[32:33], v40 offset0:128 offset1:136
  ds_read2st64_b32 a[34:35], v40 offset0:132 offset1:140
  ds_read2st64_b32 a[36:37], v42 offset0:128 offset1:136
  ds_read2st64_b32 a[38:39], v42 offset0:132 offset1:140
  s_waitcnt lgkmcnt(0)
  s_waitcnt vmcnt(28)
  s_barrier
  s_add_u32 s57, s64, 4980736
  s_add_u32 m0, s66, 65536
  s_nop 0
  buffer_load_dwordx4 v16, s[8:11], s57 offen nt lds
  s_add_u32 s57, s64, 5013504
  s_add_u32 m0, s66, 66560
  s_nop 0
  buffer_load_dwordx4 v16, s[8:11], s57 offen nt lds
  ds_read2st64_b32 a[40:41], v40 offset0:160 offset1:168
  ds_read2st64_b32 a[42:43], v40 offset0:164 offset1:172
  ds_read2st64_b32 a[44:45], v42 offset0:160 offset1:168
  ds_read2st64_b32 a[46:47], v42 offset0:164 offset1:172
  s_waitcnt lgkmcnt(0)
  s_waitcnt vmcnt(28)
  s_barrier
  s_add_u32 s57, s65, 0
  s_add_u32 m0, s66, 73728
  s_nop 0
  buffer_load_dwordx4 v17, s[20:23], s57 offen nt lds
  s_add_u32 s57, s65, 5120
  s_add_u32 m0, s66, 74752
  s_nop 0
  buffer_load_dwordx4 v17, s[20:23], s57 offen nt lds
  ds_read2st64_b32 a[48:49], v40 offset0:192 offset1:200
  ds_read2st64_b32 a[50:51], v40 offset0:196 offset1:204
  ds_read2st64_b32 a[52:53], v42 offset0:192 offset1:200
  ds_read2st64_b32 a[54:55], v42 offset0:196 offset1:204
  s_waitcnt lgkmcnt(0)
  s_waitcnt vmcnt(28)
  s_barrier
  s_add_u32 s57, s65, 40960
  s_add_u32 m0, s66, 81920
  s_nop 0
  buffer_load_dwordx4 v17, s[20:23], s57 offen nt lds
  s_add_u32 s57, s65, 46080
  s_add_u32 m0, s66, 82944
  s_nop 0
  buffer_load_dwordx4 v17, s[20:23], s57 offen nt lds
  ds_read2st64_b32 a[56:57], v40 offset0:224 offset1:232
  ds_read2st64_b32 a[58:59], v40 offset0:228 offset1:236
  ds_read2st64_b32 a[60:61], v42 offset0:224 offset1:232
  ds_read2st64_b32 a[62:63], v42 offset0:228 offset1:236
  s_waitcnt lgkmcnt(0)
  s_waitcnt vmcnt(28)
  s_barrier
  v_mov_b32 v8, 0
  buffer_load_dword v9, v8, s[28:31], 0 offen offset:64 sc1
  s_add_u32 s57, s65, 81920
  s_add_u32 m0, s66, 90112
  s_nop 0
  buffer_load_dwordx4 v17, s[20:23], s57 offen nt lds
  s_add_u32 s57, s65, 87040
  s_add_u32 m0, s66, 91136
  s_nop 0
  buffer_load_dwordx4 v17, s[20:23], s57 offen nt lds
  ds_read2st64_b32 a[64:65], v41 offset0:0 offset1:8
  ds_read2st64_b32 a[66:67], v41 offset0:4 offset1:12
  ds_read2st64_b32 a[68:69], v43 offset0:0 offset1:8
  ds_read2st64_b32 a[70:71], v43 offset0:4 offset1:12
  s_waitcnt lgkmcnt(0)
  s_waitcnt vmcnt(29)
  s_barrier
  s_add_u32 s57, s65, 256
  s_add_u32 m0, s66, 98304
  s_nop 0
  buffer_load_dwordx4 v17, s[20:23], s57 offen nt lds
  s_add_u32 s57, s65, 5376
  s_add_u32 m0, s66, 99328
  s_nop 0
  buffer_load_dwordx4 v17, s[20:23], s57 offen nt lds
  ds_read2st64_b32 a[72:73], v41 offset0:32 offset1:40
  ds_read2st64_b32 a[74:75], v41 offset0:36 offset1:44
  ds_read2st64_b32 a[76:77], v43 offset0:32 offset1:40
  ds_read2st64_b32 a[78:79], v43 offset0:36 offset1:44
  s_waitcnt lgkmcnt(0)
  s_waitcnt vmcnt(29)
  s_barrier
  s_add_u32 s57, s65, 41216
  s_add_u32 m0, s66, 106496
  s_nop 0
  buffer_load_dwordx4 v17, s[20:23], s57 offen nt lds
  s_add_u32 s57, s65, 46336
  s_add_u32 m0, s66, 107520
  s_nop 0
  buffer_load_dwordx4 v17, s[20:23], s57 offen nt lds
  ds_read2st64_b32 a[80:81], v41 offset0:64 offset1:72
  ds_read2st64_b32 a[82:83], v41 offset0:68 offset1:76
  ds_read2st64_b32 a[84:85], v43 offset0:64 offset1:72
  ds_read2st64_b32 a[86:87], v43 offset0:68 offset1:76
  s_waitcnt lgkmcnt(0)
  s_waitcnt vmcnt(29)
  s_barrier
  s_add_u32 s57, s65, 82176
  s_add_u32 m0, s66, 114688
  s_nop 0
  buffer_load_dwordx4 v17, s[20:23], s57 offen nt lds
  s_add_u32 s57, s65, 87296
  s_add_u32 m0, s66, 115712
  s_nop 0
  buffer_load_dwordx4 v17, s[20:23], s57 offen nt lds
  ds_read2st64_b32 a[88:89], v41 offset0:96 offset1:104
  ds_read2st64_b32 a[90:91], v41 offset0:100 offset1:108
  ds_read2st64_b32 a[92:93], v43 offset0:96 offset1:104
  ds_read2st64_b32 a[94:95], v43 offset0:100 offset1:108
  s_waitcnt lgkmcnt(0)
  s_waitcnt vmcnt(29)
  s_barrier
  s_add_u32 s57, s65, 512
  s_add_u32 m0, s66, 122880
  s_nop 0
  buffer_load_dwordx4 v17, s[20:23], s57 offen nt lds
  s_add_u32 s57, s65, 5632
  s_add_u32 m0, s66, 123904
  s_nop 0
  buffer_load_dwordx4 v17, s[20:23], s57 offen nt lds
  ds_read2st64_b32 a[96:97], v41 offset0:128 offset1:136
  ds_read2st64_b32 a[98:99], v41 offset0:132 offset1:140
  ds_read2st64_b32 a[100:101], v43 offset0:128 offset1:136
  ds_read2st64_b32 a[102:103], v43 offset0:132 offset1:140
  s_waitcnt lgkmcnt(0)
  s_waitcnt vmcnt(29)
  s_barrier
  s_add_u32 s57, s65, 41472
  s_add_u32 m0, s66, 131072
  s_nop 0
  buffer_load_dwordx4 v17, s[20:23], s57 offen nt lds
  s_add_u32 s57, s65, 46592
  s_add_u32 m0, s66, 132096
  s_nop 0
  buffer_load_dwordx4 v17, s[20:23], s57 offen nt lds
  ds_read2st64_b32 a[104:105], v41 offset0:160 offset1:168
  ds_read2st64_b32 a[106:107], v41 offset0:164 offset1:172
  ds_read2st64_b32 a[108:109], v43 offset0:160 offset1:168
  ds_read2st64_b32 a[110:111], v43 offset0:164 offset1:172
  s_waitcnt lgkmcnt(0)
  s_waitcnt vmcnt(29)
  s_barrier
  s_add_u32 s57, s65, 82432
  s_add_u32 m0, s66, 139264
  s_nop 0
  buffer_load_dwordx4 v17, s[20:23], s57 offen nt lds
  s_add_u32 s57, s65, 87552
  s_add_u32 m0, s66, 140288
  s_nop 0
  buffer_load_dwordx4 v17, s[20:23], s57 offen nt lds
  ds_read2st64_b32 a[112:113], v41 offset0:192 offset1:200
  ds_read2st64_b32 a[114:115], v41 offset0:196 offset1:204
  ds_read2st64_b32 a[116:117], v43 offset0:192 offset1:200
  ds_read2st64_b32 a[118:119], v43 offset0:196 offset1:204
  s_waitcnt lgkmcnt(0)
  s_waitcnt vmcnt(29)
  s_barrier
  s_add_u32 s57, s65, 768
  s_add_u32 m0, s66, 147456
  s_nop 0
  buffer_load_dwordx4 v17, s[20:23], s57 offen nt lds
  s_add_u32 s57, s65, 5888
  s_add_u32 m0, s66, 148480
  s_nop 0
  buffer_load_dwordx4 v17, s[20:23], s57 offen nt lds
  ds_read2st64_b32 a[120:121], v41 offset0:224 offset1:232
  ds_read2st64_b32 a[122:123], v41 offset0:228 offset1:236
  ds_read2st64_b32 a[124:125], v43 offset0:224 offset1:232
  ds_read2st64_b32 a[126:127], v43 offset0:228 offset1:236
  s_waitcnt lgkmcnt(0)
  s_waitcnt vmcnt(29)
  s_barrier
  s_add_u32 s57, s65, 41728
  s_add_u32 m0, s66, 155648
  s_nop 0
  buffer_load_dwordx4 v17, s[20:23], s57 offen nt lds
  s_add_u32 s57, s65, 46848
  s_add_u32 m0, s66, 156672
  s_nop 0
  buffer_load_dwordx4 v17, s[20:23], s57 offen nt lds
  ds_read2st64_b32 a[128:129], v40 offset0:0 offset1:8
  ds_read2st64_b32 a[130:131], v40 offset0:4 offset1:12
  ds_read2st64_b32 a[132:133], v42 offset0:0 offset1:8
  ds_read2st64_b32 a[134:135], v42 offset0:4 offset1:12
  s_waitcnt lgkmcnt(0)
  s_waitcnt vmcnt(29)
  s_barrier
  s_add_u32 s57, s64, 786432
  s_add_u32 m0, s66, 32768
  s_nop 0
  buffer_load_dwordx4 v16, s[8:11], s57 offen nt lds
  s_add_u32 s57, s64, 819200
  s_add_u32 m0, s66, 33792
  s_nop 0
  buffer_load_dwordx4 v16, s[8:11], s57 offen nt lds
  ds_read2st64_b32 a[136:137], v40 offset0:32 offset1:40
  ds_read2st64_b32 a[138:139], v40 offset0:36 offset1:44
  ds_read2st64_b32 a[140:141], v42 offset0:32 offset1:40
  ds_read2st64_b32 a[142:143], v42 offset0:36 offset1:44
  s_waitcnt lgkmcnt(0)
  s_waitcnt vmcnt(29)
  s_barrier
  s_add_u32 s57, s64, 1048576
  s_add_u32 m0, s66, 40960
  s_nop 0
  buffer_load_dwordx4 v16, s[12:15], s57 offen nt lds
  s_add_u32 s57, s64, 1081344
  s_add_u32 m0, s66, 41984
  s_nop 0
  buffer_load_dwordx4 v16, s[12:15], s57 offen nt lds
  ds_read2st64_b32 a[144:145], v40 offset0:64 offset1:72
  ds_read2st64_b32 a[146:147], v40 offset0:68 offset1:76
  ds_read2st64_b32 a[148:149], v42 offset0:64 offset1:72
  ds_read2st64_b32 a[150:151], v42 offset0:68 offset1:76
  s_waitcnt lgkmcnt(0)
  s_waitcnt vmcnt(29)
  s_barrier
  s_add_u32 s57, s64, 1572864
  s_add_u32 m0, s66, 49152
  s_nop 0
  buffer_load_dwordx4 v16, s[8:11], s57 offen nt lds
  s_add_u32 s57, s64, 1605632
  s_add_u32 m0, s66, 50176
  s_nop 0
  buffer_load_dwordx4 v16, s[8:11], s57 offen nt lds
  ds_read2st64_b32 a[152:153], v40 offset0:96 offset1:104
  ds_read2st64_b32 a[154:155], v40 offset0:100 offset1:108
  ds_read2st64_b32 a[156:157], v42 offset0:96 offset1:104
  ds_read2st64_b32 a[158:159], v42 offset0:100 offset1:108
  s_waitcnt lgkmcnt(0)
  s_waitcnt vmcnt(29)
  s_barrier
  s_add_u32 s57, s64, 2097152
  s_add_u32 m0, s66, 57344
  s_nop 0
  buffer_load_dwordx4 v16, s[12:15], s57 offen nt lds
  s_add_u32 s57, s64, 2129920
  s_add_u32 m0, s66, 58368
  s_nop 0
  buffer_load_dwordx4 v16, s[12:15], s57 offen nt lds
  ds_read2st64_b32 a[160:161], v40 offset0:128 offset1:136
  ds_read2st64_b32 a[162:163], v40 offset0:132 offset1:140
  ds_read2st64_b32 a[164:165], v42 offset0:128 offset1:136
  ds_read2st64_b32 a[166:167], v42 offset0:132 offset1:140
  s_waitcnt lgkmcnt(0)
  s_waitcnt vmcnt(29)
  s_barrier
  s_add_u32 s57, s64, 2359296
  s_add_u32 m0, s66, 65536
  s_nop 0
  buffer_load_dwordx4 v16, s[8:11], s57 offen nt lds
  s_add_u32 s57, s64, 2392064
  s_add_u32 m0, s66, 66560
  s_nop 0
  buffer_load_dwordx4 v16, s[8:11], s57 offen nt lds
  ds_read2st64_b32 a[168:169], v14 offset0:160 offset1:161
  ds_read2st64_b32 a[170:171], v14 offset0:162 offset1:163
  ds_read2st64_b32 a[172:173], v14 offset0:176 offset1:177
  ds_read2st64_b32 a[174:175], v14 offset0:178 offset1:179
  s_waitcnt lgkmcnt(0)
  s_waitcnt vmcnt(29)
  s_barrier
  s_add_u32 s57, s64, 2883584
  s_add_u32 m0, s66, 73728
  s_nop 0
  buffer_load_dwordx4 v16, s[12:15], s57 offen nt lds
  s_add_u32 s57, s64, 2916352
  s_add_u32 m0, s66, 74752
  s_nop 0
  buffer_load_dwordx4 v16, s[12:15], s57 offen nt lds
  ds_read2st64_b32 a[176:177], v14 offset0:192 offset1:193
  ds_read2st64_b32 a[178:179], v14 offset0:194 offset1:195
  ds_read2st64_b32 a[180:181], v14 offset0:208 offset1:209
  ds_read2st64_b32 a[182:183], v14 offset0:210 offset1:211
  s_waitcnt lgkmcnt(0)
  s_waitcnt vmcnt(28)
  s_barrier
  s_add_u32 s57, s64, 3407872
  s_add_u32 m0, s66, 81920
  s_nop 0
  buffer_load_dwordx4 v16, s[8:11], s57 offen nt lds
  s_add_u32 s57, s64, 3440640
  s_add_u32 m0, s66, 82944
  s_nop 0
  buffer_load_dwordx4 v16, s[8:11], s57 offen nt lds
  ds_read2st64_b32 a[184:185], v14 offset0:224 offset1:225
  ds_read2st64_b32 a[186:187], v14 offset0:226 offset1:227
  ds_read2st64_b32 a[188:189], v14 offset0:240 offset1:241
  ds_read2st64_b32 a[190:191], v14 offset0:242 offset1:243
  s_waitcnt lgkmcnt(0)
  s_waitcnt vmcnt(28)
  s_barrier
  s_add_u32 s57, s64, 3670016
  s_add_u32 m0, s66, 90112
  s_nop 0
  buffer_load_dwordx4 v16, s[12:15], s57 offen nt lds
  s_add_u32 s57, s64, 3702784
  s_add_u32 m0, s66, 91136
  s_nop 0
  buffer_load_dwordx4 v16, s[12:15], s57 offen nt lds
  ds_read2st64_b32 a[192:193], v15 offset0:0 offset1:1
  ds_read2st64_b32 a[194:195], v15 offset0:2 offset1:3
  ds_read2st64_b32 a[196:197], v15 offset0:16 offset1:17
  ds_read2st64_b32 a[198:199], v15 offset0:18 offset1:19
  s_waitcnt lgkmcnt(0)
  s_waitcnt vmcnt(28)
  s_barrier
  s_add_u32 s57, s64, 4194304
  s_add_u32 m0, s66, 98304
  s_nop 0
  buffer_load_dwordx4 v16, s[8:11], s57 offen nt lds
  s_add_u32 s57, s64, 4227072
  s_add_u32 m0, s66, 99328
  s_nop 0
  buffer_load_dwordx4 v16, s[8:11], s57 offen nt lds
  ds_read2st64_b32 a[200:201], v15 offset0:32 offset1:33
  ds_read2st64_b32 a[202:203], v15 offset0:34 offset1:35
  ds_read2st64_b32 a[204:205], v15 offset0:48 offset1:49
  ds_read2st64_b32 a[206:207], v15 offset0:50 offset1:51
  s_waitcnt lgkmcnt(0)
  s_waitcnt vmcnt(28)
  s_barrier
  s_add_u32 s57, s64, 4456448
  s_add_u32 m0, s66, 106496
  s_nop 0
  buffer_load_dwordx4 v16, s[12:15], s57 offen nt lds
  s_add_u32 s57, s64, 4489216
  s_add_u32 m0, s66, 107520
  s_nop 0
  buffer_load_dwordx4 v16, s[12:15], s57 offen nt lds
  ds_read2st64_b32 a[208:209], v15 offset0:64 offset1:65
  ds_read2st64_b32 a[210:211], v15 offset0:66 offset1:67
  ds_read2st64_b32 a[212:213], v15 offset0:80 offset1:81
  ds_read2st64_b32 a[214:215], v15 offset0:82 offset1:83
  s_waitcnt lgkmcnt(0)
  s_waitcnt vmcnt(28)
  s_barrier
  s_add_u32 s57, s64, 4980736
  s_add_u32 m0, s66, 114688
  s_nop 0
  buffer_load_dwordx4 v16, s[12:15], s57 offen nt lds
  s_add_u32 s57, s64, 5013504
  s_add_u32 m0, s66, 115712
  s_nop 0
  buffer_load_dwordx4 v16, s[12:15], s57 offen nt lds
  ds_read2st64_b32 a[216:217], v15 offset0:96 offset1:97
  ds_read2st64_b32 a[218:219], v15 offset0:98 offset1:99
  ds_read2st64_b32 a[220:221], v15 offset0:112 offset1:113
  ds_read2st64_b32 a[222:223], v15 offset0:114 offset1:115
  s_waitcnt lgkmcnt(0)
  s_waitcnt vmcnt(28)
  s_barrier
  s_add_u32 s57, s65, 122880
  s_add_u32 m0, s66, 122880
  s_nop 0
  buffer_load_dwordx4 v17, s[20:23], s57 offen nt lds
  s_add_u32 s57, s65, 128000
  s_add_u32 m0, s66, 123904
  s_nop 0
  buffer_load_dwordx4 v17, s[20:23], s57 offen nt lds
  ds_read2st64_b32 a[224:225], v15 offset0:128 offset1:129
  ds_read2st64_b32 a[226:227], v15 offset0:130 offset1:131
  ds_read2st64_b32 a[228:229], v15 offset0:144 offset1:145
  ds_read2st64_b32 a[230:231], v15 offset0:146 offset1:147
  s_waitcnt lgkmcnt(0)
  s_waitcnt vmcnt(28)
  s_barrier
  s_add_u32 s57, s65, 123136
  s_add_u32 m0, s66, 131072
  s_nop 0
  buffer_load_dwordx4 v17, s[20:23], s57 offen nt lds
  s_add_u32 s57, s65, 128256
  s_add_u32 m0, s66, 132096
  s_nop 0
  buffer_load_dwordx4 v17, s[20:23], s57 offen nt lds
  ds_read2st64_b32 a[232:233], v15 offset0:160 offset1:161
  ds_read2st64_b32 a[234:235], v15 offset0:162 offset1:163
  ds_read2st64_b32 a[236:237], v15 offset0:176 offset1:177
  ds_read2st64_b32 a[238:239], v15 offset0:178 offset1:179
  s_waitcnt lgkmcnt(0)
  s_waitcnt vmcnt(28)
  s_barrier
  buffer_load_dword v10, v8, s[4:7], s62 offen sc1
  s_add_u32 s57, s65, 123392
  s_add_u32 m0, s66, 139264
  s_nop 0
  buffer_load_dwordx4 v17, s[20:23], s57 offen nt lds
  s_add_u32 s57, s65, 128512
  s_add_u32 m0, s66, 140288
  s_nop 0
  buffer_load_dwordx4 v17, s[20:23], s57 offen nt lds
  ds_read2st64_b32 a[240:241], v15 offset0:192 offset1:193
  ds_read2st64_b32 a[242:243], v15 offset0:194 offset1:195
  ds_read2st64_b32 a[244:245], v15 offset0:208 offset1:209
  ds_read2st64_b32 a[246:247], v15 offset0:210 offset1:211
  s_waitcnt lgkmcnt(0)
  s_waitcnt vmcnt(29)
  s_barrier
  s_add_u32 s57, s65, 123648
  s_add_u32 m0, s66, 147456
  s_nop 0
  buffer_load_dwordx4 v17, s[20:23], s57 offen nt lds
  s_add_u32 s57, s65, 128768
  s_add_u32 m0, s66, 148480
  s_nop 0
  buffer_load_dwordx4 v17, s[20:23], s57 offen nt lds
  ds_read2st64_b32 a[248:249], v15 offset0:224 offset1:225
  ds_read2st64_b32 a[250:251], v15 offset0:226 offset1:227
  ds_read2st64_b32 a[252:253], v15 offset0:240 offset1:241
  ds_read2st64_b32 a[254:255], v15 offset0:242 offset1:243
  s_waitcnt lgkmcnt(0)
  s_waitcnt vmcnt(29)
  s_barrier
  s_add_u32 s57, s65, 123904
  s_add_u32 m0, s66, 155648
  s_nop 0
  buffer_load_dwordx4 v17, s[20:23], s57 offen nt lds
  s_add_u32 s57, s65, 129024
  s_add_u32 m0, s66, 156672
  s_nop 0
  buffer_load_dwordx4 v17, s[20:23], s57 offen nt lds
  ds_read2st64_b32 v[24:25], v40 offset0:0 offset1:8
  ds_read2st64_b32 v[26:27], v40 offset0:4 offset1:12
  ds_read2st64_b32 v[28:29], v42 offset0:0 offset1:8
  ds_read2st64_b32 v[30:31], v42 offset0:4 offset1:12
  s_waitcnt lgkmcnt(0)
  s_waitcnt vmcnt(29)
  s_barrier
  ds_write_b128 v7, v[24:27] offset:0
  ds_write_b128 v7, v[28:31] offset:1024
  ds_read2st64_b32 v[32:33], v40 offset0:32 offset1:40
  ds_read2st64_b32 v[34:35], v40 offset0:36 offset1:44
  ds_read2st64_b32 v[36:37], v42 offset0:32 offset1:40
  ds_read2st64_b32 v[38:39], v42 offset0:36 offset1:44
  s_waitcnt lgkmcnt(0)
  s_waitcnt vmcnt(27)
  s_barrier
  ds_write_b128 v7, v[32:35] offset:8192
  ds_write_b128 v7, v[36:39] offset:9216
  ds_read2st64_b32 v[24:25], v40 offset0:64 offset1:72
  ds_read2st64_b32 v[26:27], v40 offset0:68 offset1:76
  ds_read2st64_b32 v[28:29], v42 offset0:64 offset1:72
  ds_read2st64_b32 v[30:31], v42 offset0:68 offset1:76
  s_waitcnt lgkmcnt(0)
  s_waitcnt vmcnt(25)
  s_barrier
  ds_write_b128 v7, v[24:27] offset:16384
  ds_write_b128 v7, v[28:31] offset:17408
  ds_read2st64_b32 v[32:33], v40 offset0:96 offset1:104
  ds_read2st64_b32 v[34:35], v40 offset0:100 offset1:108
  ds_read2st64_b32 v[36:37], v42 offset0:96 offset1:104
  ds_read2st64_b32 v[38:39], v42 offset0:100 offset1:108
  s_waitcnt lgkmcnt(0)
  s_waitcnt vmcnt(23)
  s_barrier
  ds_write_b128 v7, v[32:35] offset:24576
  ds_write_b128 v7, v[36:39] offset:25600
  ds_read2st64_b32 v[24:25], v40 offset0:128 offset1:136
  ds_read2st64_b32 v[26:27], v40 offset0:132 offset1:140
  ds_read2st64_b32 v[28:29], v42 offset0:128 offset1:136
  ds_read2st64_b32 v[30:31], v42 offset0:132 offset1:140
  s_waitcnt lgkmcnt(0)
  s_waitcnt vmcnt(21)
  s_barrier
  ds_write_b128 v7, v[24:27] offset:32768
  ds_write_b128 v7, v[28:31] offset:33792
  ds_read2st64_b32 v[32:33], v40 offset0:160 offset1:168
  ds_read2st64_b32 v[34:35], v40 offset0:164 offset1:172
  ds_read2st64_b32 v[36:37], v42 offset0:160 offset1:168
  ds_read2st64_b32 v[38:39], v42 offset0:164 offset1:172
  s_waitcnt lgkmcnt(0)
  s_waitcnt vmcnt(19)
  s_barrier
  ds_write_b128 v7, v[32:35] offset:40960
  ds_write_b128 v7, v[36:39] offset:41984
  ds_read2st64_b32 v[24:25], v40 offset0:192 offset1:200
  ds_read2st64_b32 v[26:27], v40 offset0:196 offset1:204
  ds_read2st64_b32 v[28:29], v42 offset0:192 offset1:200
  ds_read2st64_b32 v[30:31], v42 offset0:196 offset1:204
  s_waitcnt lgkmcnt(0)
  s_waitcnt vmcnt(17)
  s_barrier
  ds_write_b128 v7, v[24:27] offset:49152
  ds_write_b128 v7, v[28:31] offset:50176
  ds_read2st64_b32 v[32:33], v40 offset0:224 offset1:232
  ds_read2st64_b32 v[34:35], v40 offset0:228 offset1:236
  ds_read2st64_b32 v[36:37], v42 offset0:224 offset1:232
  ds_read2st64_b32 v[38:39], v42 offset0:228 offset1:236
  s_waitcnt lgkmcnt(0)
  s_waitcnt vmcnt(15)
  s_barrier
  ds_write_b128 v7, v[32:35] offset:57344
  ds_write_b128 v7, v[36:39] offset:58368
  ds_read2st64_b32 v[24:25], v41 offset0:0 offset1:8
  ds_read2st64_b32 v[26:27], v41 offset0:4 offset1:12
  ds_read2st64_b32 v[28:29], v43 offset0:0 offset1:8
  ds_read2st64_b32 v[30:31], v43 offset0:4 offset1:12
  s_waitcnt lgkmcnt(0)
  s_waitcnt vmcnt(13)
  s_barrier
  v_add_u32 v7, 0x10000, v7
  ds_write_b128 v7, v[24:27] offset:0
  ds_write_b128 v7, v[28:31] offset:1024
  ds_read2st64_b32 v[32:33], v41 offset0:32 offset1:40
  ds_read2st64_b32 v[34:35], v41 offset0:36 offset1:44
  ds_read2st64_b32 v[36:37], v43 offset0:32 offset1:40
  ds_read2st64_b32 v[38:39], v43 offset0:36 offset1:44
  s_waitcnt lgkmcnt(0)
  s_waitcnt vmcnt(11)
  s_barrier
  ds_write_b128 v7, v[32:35] offset:8192
  ds_write_b128 v7, v[36:39] offset:9216
  ds_read2st64_b32 v[24:25], v41 offset0:64 offset1:72
  ds_read2st64_b32 v[26:27], v41 offset0:68 offset1:76
  ds_read2st64_b32 v[28:29], v43 offset0:64 offset1:72
  ds_read2st64_b32 v[30:31], v43 offset0:68 offset1:76
  s_waitcnt lgkmcnt(0)
  s_waitcnt vmcnt(9)
  s_barrier
  ds_write_b128 v7, v[24:27] offset:16384
  ds_write_b128 v7, v[28:31] offset:17408
  ds_read2st64_b32 v[32:33], v15 offset0:96 offset1:97
  ds_read2st64_b32 v[34:35], v15 offset0:98 offset1:99
  ds_read2st64_b32 v[36:37], v15 offset0:112 offset1:113
  ds_read2st64_b32 v[38:39], v15 offset0:114 offset1:115
  s_waitcnt lgkmcnt(0)
  s_waitcnt vmcnt(7)
  s_barrier
  ds_write_b128 v7, v[32:35] offset:24576
  ds_write_b128 v7, v[36:39] offset:25600
  ds_read2st64_b32 v[24:25], v15 offset0:128 offset1:129
  ds_read2st64_b32 v[26:27], v15 offset0:130 offset1:131
  ds_read2st64_b32 v[28:29], v15 offset0:144 offset1:145
  ds_read2st64_b32 v[30:31], v15 offset0:146 offset1:147
  s_waitcnt lgkmcnt(0)
  s_waitcnt vmcnt(4)
  s_barrier
  ds_write_b128 v7, v[24:27] offset:32768
  ds_write_b128 v7, v[28:31] offset:33792
  ds_read2st64_b32 v[32:33], v15 offset0:160 offset1:161
  ds_read2st64_b32 v[34:35], v15 offset0:162 offset1:163
  ds_read2st64_b32 v[36:37], v15 offset0:176 offset1:177
  ds_read2st64_b32 v[38:39], v15 offset0:178 offset1:179
  s_waitcnt lgkmcnt(0)
  s_waitcnt vmcnt(2)
  s_barrier
  ds_write_b128 v7, v[32:35] offset:40960
  ds_write_b128 v7, v[36:39] offset:41984
  ds_read2st64_b32 v[24:25], v15 offset0:192 offset1:193
  ds_read2st64_b32 v[26:27], v15 offset0:194 offset1:195
  ds_read2st64_b32 v[28:29], v15 offset0:208 offset1:209
  ds_read2st64_b32 v[30:31], v15 offset0:210 offset1:211
  s_waitcnt lgkmcnt(0)
  s_waitcnt vmcnt(0)
  s_barrier
  ds_write_b128 v7, v[24:27] offset:49152
  ds_write_b128 v7, v[28:31] offset:50176
  ds_read2st64_b32 v[32:33], v15 offset0:224 offset1:225
  ds_read2st64_b32 v[34:35], v15 offset0:226 offset1:227
  ds_read2st64_b32 v[36:37], v15 offset0:240 offset1:241
  ds_read2st64_b32 v[38:39], v15 offset0:242 offset1:243
  s_waitcnt lgkmcnt(0)
  s_barrier
  ds_write_b128 v7, v[32:35] offset:57344
  ds_write_b128 v7, v[36:39] offset:58368
  v_subrev_u32 v7, 0x10000, v7
  s_waitcnt vmcnt(0)
  v_readfirstlane_b32 s58, v9
  v_readfirstlane_b32 s60, v10
  s_nop 3
  s_cmp_ge_u32 s58, 192
  s_cbranch_scc1 Lch_teamok
  s_mov_b32 s60, 0
Lch_team:
  buffer_load_dword v9, v8, s[28:31], 0 offen offset:64 sc1
  s_waitcnt vmcnt(0)
  v_readfirstlane_b32 s58, v9
  s_nop 3
  s_cmp_ge_u32 s58, 192
  s_cbranch_scc1 Lch_teamok
  s_sub_u32 s55, s55, 1
  s_cbranch_scc0 Lch_team
  s_mov_b32 s56, 1
Lch_teamok:
  s_mov_b32 s59, 1
  s_cmp_ge_u32 s60, s59
  s_cbranch_scc1 Lch_g1first_ok
Lch_g1first:
  buffer_load_dword v9, v8, s[4:7], s62 offen sc1
  s_waitcnt vmcnt(0)
  v_readfirstlane_b32 s60, v9
  s_nop 3
  s_cmp_ge_u32 s60, s59
  s_cbranch_scc1 Lch_g1first_ok
  s_cmp_lg_u32 s56, 0
  s_cbranch_scc1 Lch_g1first_ok
  s_sub_u32 s55, s55, 1
  s_cbranch_scc0 Lch_g1first
  s_mov_b32 s56, 1
Lch_g1first_ok:
  s_lshl_b32 s57, s34, 11
  s_add_u32 s26, s57, 16384
  s_add_u32 s27, s57, 24576
  s_mov_b32 m0, s26
  s_nop 0
  buffer_load_dwordx4 v0, s[4:7], s48 offen sc1 lds
  buffer_load_dwordx4 v0, s[4:7], s48 offen offset:1024 sc1 lds
  s_add_u32 s16, s51, 0
  s_add_u32 s17, s51, 8192
  s_add_u32 s18, s51, 16384
  s_add_u32 s19, s51, 24576
  s_add_u32 s20, s51, 32768
  s_add_u32 s21, s51, 40960
  s_add_u32 s22, s51, 49152
  s_add_u32 s23, s51, 57344
  s_add_u32 s24, s51, 65536
  s_add_u32 s25, s51, 73728
  s_lshl_b32 s57, s34, 11
  s_add_u32 s26, s57, 16384
  s_add_u32 s27, s57, 24576
  buffer_load_dwordx4 v[8:11], v0, s[4:7], s16 offen offset:0 sc1
  buffer_load_dwordx4 v[12:15], v0, s[4:7], s16 offen offset:1024 sc1
  buffer_load_dwordx4 v[16:19], v0, s[4:7], s17 offen offset:0 sc1
  buffer_load_dwordx4 v[20:23], v0, s[4:7], s17 offen offset:1024 sc1
  ds_read_b128 v[40:43], v7 offset:0
  ds_read_b128 v[44:47], v7 offset:1024
  ds_read_b128 v[48:51], v7 offset:8192
  ds_read_b128 v[52:55], v7 offset:9216
  v_mov_b64 v[68:69], 0
  v_mov_b64 v[70:71], 0
  v_mov_b64 v[72:73], 0
  v_mov_b64 v[74:75], 0
  v_mov_b64 v[76:77], 0
  v_mov_b64 v[78:79], 0
  s_waitcnt vmcnt(0) lgkmcnt(0)
Lch_step:
  s_barrier
  ds_read_b128 v[56:59], v4 offset:0
  ds_read_b128 v[60:63], v4 offset:512
  s_add_u32 s59, s35, 2
  s_min_u32 s59, s59, 64
  s_cmp_ge_u32 s60, s59
  s_cbranch_scc1 Lch_g1_ok
  v_mov_b32 v64, 0
Lch_g1:
  buffer_load_dword v65, v64, s[4:7], s62 offen sc1
  s_waitcnt vmcnt(0)
  v_readfirstlane_b32 s60, v65
  s_nop 3
  s_cmp_ge_u32 s60, s59
  s_cbranch_scc1 Lch_g1_ok
  s_cmp_lg_u32 s56, 0
  s_cbranch_scc1 Lch_g1_ok
  s_sub_u32 s55, s55, 1
  s_cbranch_scc0 Lch_g1
  s_mov_b32 s56, 1
Lch_g1_ok:
  s_waitcnt lgkmcnt(1)
  v_smfmac_f32_16x16x64_bf16 v[68:71], v[56:59], v[8:15], v5
  ds_read_b128 v[64:67], v4 offset:1024
  v_smfmac_f32_16x16x64_bf16 v[72:75], v[56:59], v[16:23], v5
  buffer_load_dwordx4 v[24:27], v0, s[4:7], s18 offen offset:0 sc1
  v_smfmac_f32_16x16x64_bf16 v[76:79], v[56:59], v[80:87], v5
  ds_read_b128 v[56:59], v4 offset:1536
  s_waitcnt lgkmcnt(2)
  v_smfmac_f32_16x16x64_bf16 v[68:71], v[60:63], v[88:95], v5
  v_smfmac_f32_16x16x64_bf16 v[72:75], v[60:63], v[96:103], v5
  buffer_load_dwordx4 v[28:31], v0, s[4:7], s18 offen offset:1024 sc1
  v_smfmac_f32_16x16x64_bf16 v[76:79], v[60:63], v[104:111], v5
  ds_read_b128 v[60:63], v4 offset:2048
  s_waitcnt lgkmcnt(2)
  v_smfmac_f32_16x16x64_bf16 v[68:71], v[64:67], v[112:119], v5
  v_smfmac_f32_16x16x64_bf16 v[72:75], v[64:67], v[120:127], v5
  buffer_load_dwordx4 v[32:35], v0, s[4:7], s19 offen offset:0 sc1
  v_smfmac_f32_16x16x64_bf16 v[76:79], v[64:67], v[128:135], v5
  ds_read_b128 v[64:67], v4 offset:2560
  s_waitcnt lgkmcnt(2)
  v_smfmac_f32_16x16x64_bf16 v[68:71], v[56:59], v[40:47], v5
  ds_read_b128 v[40:43], v7 offset:16384
  v_smfmac_f32_16x16x64_bf16 v[72:75], v[56:59], v[136:143], v5
  buffer_load_dwordx4 v[36:39], v0, s[4:7], s19 offen offset:1024 sc1
  v_smfmac_f32_16x16x64_bf16 v[76:79], v[56:59], v[144:151], v5
  ds_read_b128 v[56:59], v4 offset:3072
  s_waitcnt lgkmcnt(3)
  v_smfmac_f32_16x16x64_bf16 v[68:71], v[60:63], v[152:159], v5
  ds_read_b128 v[44:47], v7 offset:17408
  v_smfmac_f32_16x16x64_bf16 v[72:75], v[60:63], v[48:55], v5
  buffer_load_dwordx4 v[8:11], v0, s[4:7], s20 offen offset:0 sc1
  v_smfmac_f32_16x16x64_bf16 v[76:79], v[60:63], v[160:167], v5
  ds_read_b128 v[60:63], v4 offset:3584
  s_waitcnt lgkmcnt(4)
  v_smfmac_f32_16x16x64_bf16 v[68:71], v[64:67], v[168:175], v5
  ds_read_b128 v[48:51], v7 offset:24576
  v_smfmac_f32_16x16x64_bf16 v[72:75], v[64:67], v[176:183], v5
  buffer_load_dwordx4 v[12:15], v0, s[4:7], s20 offen offset:1024 sc1
  v_smfmac_f32_16x16x64_bf16 v[76:79], v[64:67], v[184:191], v5
  ds_read_b128 v[64:67], v4 offset:4096
  s_waitcnt lgkmcnt(3)
  v_smfmac_f32_16x16x64_bf16 v[68:71], v[56:59], v[40:47], v5
  ds_read_b128 v[52:55], v7 offset:25600
  v_smfmac_f32_16x16x64_bf16 v[72:75], v[56:59], v[192:199], v5
  buffer_load_dwordx4 v[16:19], v0, s[4:7], s21 offen offset:0 sc1
  v_smfmac_f32_16x16x64_bf16 v[76:79], v[56:59], v[200:207], v5
  ds_read_b128 v[56:59], v4 offset:4608
  s_waitcnt lgkmcnt(4)
  v_smfmac_f32_16x16x64_bf16 v[68:71], v[60:63], v[208:215], v5
  ds_read_b128 v[40:43], v7 offset:32768
  v_smfmac_f32_16x16x64_bf16 v[72:75], v[60:63], v[216:223], v5
  buffer_load_dwordx4 v[20:23], v0, s[4:7], s21 offen offset:1024 sc1
  v_smfmac_f32_16x16x64_bf16 v[76:79], v[60:63], v[224:231], v5
  ds_read_b128 v[60:63], v4 offset:5120
  s_waitcnt lgkmcnt(4)
  v_smfmac_f32_16x16x64_bf16 v[68:71], v[64:67], v[232:239], v5
  ds_read_b128 v[44:47], v7 offset:33792
  s_waitcnt lgkmcnt(4)
  v_smfmac_f32_16x16x64_bf16 v[72:75], v[64:67], v[48:55], v5
  s_mov_b32 m0, s27
  s_nop 0
  buffer_load_dwordx4 v0, s[4:7], s49 offen offset:0 sc1 nt lds
  v_smfmac_f32_16x16x64_bf16 v[76:79], v[64:67], v[240:247], v5
  ds_read_b128 v[64:67], v4 offset:5632
  s_waitcnt lgkmcnt(1)
  v_smfmac_f32_16x16x64_bf16 v[68:71], v[56:59], v[40:47], v5
  ds_read_b128 v[48:51], v7 offset:40960
  v_smfmac_f32_16x16x64_bf16 v[72:75], v[56:59], v[248:255], v5
  ds_read_b128 v[52:55], v7 offset:41984
  v_smfmac_f32_16x16x64_bf16 v[76:79], v[56:59], a[0:7], v5
  ds_read_b128 v[56:59], v4 offset:6144
  v_smfmac_f32_16x16x64_bf16 v[68:71], v[60:63], a[8:15], v5
  buffer_load_dwordx4 v0, s[4:7], s49 offen offset:1024 sc1 nt lds
  v_smfmac_f32_16x16x64_bf16 v[72:75], v[60:63], a[16:23], v5
  ds_read_b128 v[40:43], v7 offset:49152
  v_smfmac_f32_16x16x64_bf16 v[76:79], v[60:63], a[24:31], v5
  ds_read_b128 v[60:63], v4 offset:6656
  s_waitcnt lgkmcnt(5)
  v_smfmac_f32_16x16x64_bf16 v[68:71], v[64:67], a[32:39], v5
  s_mov_b64 exec, 1
  buffer_atomic_inc v5, v0, s[4:7], s63 offen sc1
  s_mov_b64 exec, -1
  s_waitcnt lgkmcnt(3)
  v_smfmac_f32_16x16x64_bf16 v[72:75], v[64:67], v[48:55], v5
  ds_read_b128 v[44:47], v7 offset:50176
  v_smfmac_f32_16x16x64_bf16 v[76:79], v[64:67], a[40:47], v5
  ds_read_b128 v[64:67], v4 offset:7168
  s_waitcnt lgkmcnt(4)
  v_smfmac_f32_16x16x64_bf16 v[68:71], v[56:59], a[48:55], v5
  ds_read_b128 v[48:51], v7 offset:57344
  v_smfmac_f32_16x16x64_bf16 v[72:75], v[56:59], a[56:63], v5
  ds_read_b128 v[52:55], v7 offset:58368
  v_smfmac_f32_16x16x64_bf16 v[76:79], v[56:59], a[64:71], v5
  ds_read_b128 v[56:59], v4 offset:7680
  s_waitcnt lgkmcnt(4)
  v_smfmac_f32_16x16x64_bf16 v[68:71], v[60:63], v[40:47], v5
  v_add_u32 v7, 0x10000, v7
  ds_read_b128 v[40:43], v7 offset:0
  v_smfmac_f32_16x16x64_bf16 v[72:75], v[60:63], a[72:79], v5
  ds_read_b128 v[44:47], v7 offset:1024
  v_smfmac_f32_16x16x64_bf16 v[76:79], v[60:63], a[80:87], v5
  ds_read_b128 v[60:63], v4 offset:8192
  s_waitcnt lgkmcnt(6)
  v_smfmac_f32_16x16x64_bf16 v[68:71], v[64:67], a[88:95], v5
  s_waitcnt lgkmcnt(4)
  v_smfmac_f32_16x16x64_bf16 v[72:75], v[64:67], v[48:55], v5
  ds_read_b128 v[48:51], v7 offset:8192
  v_smfmac_f32_16x16x64_bf16 v[76:79], v[64:67], a[96:103], v5
  ds_read_b128 v[64:67], v4 offset:8704
  s_waitcnt lgkmcnt(5)
  v_smfmac_f32_16x16x64_bf16 v[68:71], v[56:59], a[104:111], v5
  ds_read_b128 v[52:55], v7 offset:9216
  v_smfmac_f32_16x16x64_bf16 v[72:75], v[56:59], a[112:119], v5
  v_smfmac_f32_16x16x64_bf16 v[76:79], v[56:59], a[120:127], v5
  ds_read_b128 v[56:59], v4 offset:9216
  s_waitcnt lgkmcnt(4)
  v_smfmac_f32_16x16x64_bf16 v[68:71], v[60:63], v[40:47], v5
  ds_read_b128 v[40:43], v7 offset:16384
  v_smfmac_f32_16x16x64_bf16 v[72:75], v[60:63], a[128:135], v5
  ds_read_b128 v[44:47], v7 offset:17408
  s_waitcnt vmcnt(9)
  v_smfmac_f32_16x16x64_bf16 v[76:79], v[60:63], v[24:31], v5
  ds_read_b128 v[60:63], v4 offset:9728
  s_waitcnt lgkmcnt(5)
  v_smfmac_f32_16x16x64_bf16 v[68:71], v[64:67], a[136:143], v5
  ds_read_b128 v[24:27], v0 offset:20480
  s_waitcnt lgkmcnt(5)
  v_smfmac_f32_16x16x64_bf16 v[72:75], v[64:67], v[48:55], v5
  ds_read_b128 v[28:31], v0 offset:21504
  s_waitcnt lgkmcnt(5)
  v_smfmac_f32_16x16x64_bf16 v[68:71], v[56:59], a[144:151], v5
  v_smfmac_f32_16x16x64_bf16 v[72:75], v[56:59], a[152:159], v5
  s_waitcnt lgkmcnt(2)
  v_smfmac_f32_16x16x64_bf16 v[68:71], v[60:63], a[160:167], v5
  v_smfmac_f32_16x16x64_bf16 v[72:75], v[60:63], v[40:47], v5
  s_waitcnt vmcnt(7)
  v_smfmac_f32_16x16x64_bf16 v[76:79], v[64:67], v[32:39], v5
  ds_read_b128 v[32:35], v0 offset:22528
  ds_read_b128 v[36:39], v0 offset:23552
  s_waitcnt vmcnt(5)
  v_smfmac_f32_16x16x64_bf16 v[76:79], v[56:59], v[8:15], v5
  ds_read_b128 v[8:11], v0 offset:16384
  ds_read_b128 v[12:15], v0 offset:17408
  s_waitcnt vmcnt(3)
  v_smfmac_f32_16x16x64_bf16 v[76:79], v[60:63], v[16:23], v5
  ds_read_b128 v[16:19], v0 offset:18432
  ds_read_b128 v[20:23], v0 offset:19456
  v_cvt_pk_bf16_f32 v68, v68, v69
  v_cvt_pk_bf16_f32 v69, v70, v71
  v_cvt_pk_bf16_f32 v72, v72, v73
  v_cvt_pk_bf16_f32 v73, v74, v75
  ds_write_b64 v3, v[68:69] offset:10240
  ds_write_b64 v3, v[72:73] offset:12288
  buffer_store_dwordx2 v[72:73], v3, s[4:7], s50 offen sc1
  v_cvt_pk_bf16_f32 v76, v76, v77
  v_cvt_pk_bf16_f32 v77, v78, v79
  s_cmp_eq_u32 s35, 63
  s_cbranch_scc1 Lch_last
  s_waitcnt lgkmcnt(0)
  s_barrier
  ds_read_b64_tr_b16 v[40:41], v2 offset:10240
  ds_read_b64_tr_b16 v[42:43], v2 offset:10256
  ds_read_b64_tr_b16 v[44:45], v2 offset:10752
  ds_read_b64_tr_b16 v[46:47], v2 offset:10768
  buffer_store_dwordx2 v[76:77], v3, s[4:7], s50 offen offset:2048 sc1
  s_add_u32 s48, s48, 262144
  s_mov_b32 m0, s26
  s_waitcnt lgkmcnt(2)
  v_mfma_f32_16x16x32_bf16 v[64:67], v[24:27], v[40:43], 0
  ds_read_b64_tr_b16 v[48:49], v2 offset:11264
  ds_read_b64_tr_b16 v[50:51], v2 offset:11280
  v_mfma_f32_16x16x32_bf16 v[60:63], v[8:11], v[40:43], 0
  ds_read_b64_tr_b16 v[52:53], v2 offset:11776
  ds_read_b64_tr_b16 v[54:55], v2 offset:11792
  s_waitcnt lgkmcnt(4)
  v_mfma_f32_16x16x32_bf16 v[64:67], v[28:31], v[44:47], v[64:67]
  ds_read_b64_tr_b16 v[68:69], v2 offset:12288
  ds_read_b64_tr_b16 v[70:71], v2 offset:12304
  v_mfma_f32_16x16x32_bf16 v[60:63], v[12:15], v[44:47], v[60:63]
  ds_read_b64_tr_b16 v[14:15], v2 offset:13840
  ds_read_b64_tr_b16 v[12:13], v2 offset:13824
  s_waitcnt lgkmcnt(6)
  v_mfma_f32_16x16x32_bf16 v[64:67], v[32:35], v[48:51], v[64:67]
  ds_read_b64_tr_b16 v[10:11], v2 offset:13328
  ds_read_b64_tr_b16 v[8:9], v2 offset:13312
  v_mfma_f32_16x16x32_bf16 v[60:63], v[16:19], v[48:51], v[60:63]
  ds_read_b64_tr_b16 v[72:73], v2 offset:12800
  ds_read_b64_tr_b16 v[74:75], v2 offset:12816
  s_waitcnt lgkmcnt(8)
  v_mfma_f32_16x16x32_bf16 v[64:67], v[36:39], v[52:55], v[64:67]
  v_mov_b64 v[78:79], 0
  v_mov_b32_dpp v78, v76 quad_perm:[0,1,2,3] row_mask:0xc bank_mask:0xf
  v_mfma_f32_16x16x32_bf16 v[60:63], v[20:23], v[52:55], v[60:63]
  v_mov_b32_dpp v79, v77 quad_perm:[0,1,2,3] row_mask:0xc bank_mask:0xf
  s_waitcnt lgkmcnt(6)
  v_mfma_f32_16x16x32_bf16 v[56:59], v[68:71], v[40:43], 0
  buffer_load_dwordx4 v[24:27], v0, s[4:7], s24 offen offset:0 sc1
  s_waitcnt lgkmcnt(0)
  v_mfma_f32_16x16x32_bf16 v[56:59], v[72:75], v[44:47], v[56:59]
  s_waitcnt vmcnt(4)
  v_add_u32 v40, s27, v0
  ds_read_b128 v[44:47], v40 offset:1024
  v_mfma_f32_16x16x32_bf16 v[56:59], v[8:11], v[48:51], v[56:59]
  ds_read_b128 v[40:43], v40
  v_mfma_f32_16x16x32_bf16 v[56:59], v[12:15], v[52:55], v[56:59]
  buffer_load_dwordx4 v[8:11], v0, s[4:7], s22 offen offset:0 sc1
  s_nop 1
  ds_read_b128 v[48:51], v7 offset:24576
  ds_read_b128 v[52:55], v7 offset:25600
  v_max3_f32 v72, v64, v65, v66
  v_max3_f32 v72, v72, v67, v60
  v_max3_f32 v72, v72, v61, v62
  v_max3_f32 v72, v72, v63, v56
  v_max3_f32 v72, v72, v57, v58
  v_max_f32 v72, v72, v59
  v_mov_b32 v73, v72
  buffer_load_dwordx4 v[28:31], v0, s[4:7], s24 offen offset:1024 sc1
  v_mov_b32 v69, 0
  v_permlane32_swap_b32 v72, v73
  v_max_f32 v72, v72, v73
  v_mov_b32 v73, v72
  v_mov_b32_dpp v76, v69 quad_perm:[0,1,2,3] row_mask:0xc bank_mask:0xf
  v_mov_b32_dpp v77, v69 quad_perm:[0,1,2,3] row_mask:0xc bank_mask:0xf
  v_permlane16_swap_b32 v72, v73
  v_max_f32 v72, v72, v73
  v_mul_f32 v72, s54, v72
  v_fma_f32 v64, v64, s54, -v72
  v_fma_f32 v65, v65, s54, -v72
  v_fma_f32 v66, v66, s54, -v72
  v_fma_f32 v67, v67, s54, -v72
  v_fma_f32 v60, v60, s54, -v72
  v_fma_f32 v61, v61, s54, -v72
  buffer_load_dwordx4 v[12:15], v0, s[4:7], s22 offen offset:1024 sc1
  v_fma_f32 v62, v62, s54, -v72
  v_fma_f32 v63, v63, s54, -v72
  v_fma_f32 v56, v56, s54, -v72
  v_fma_f32 v57, v57, s54, -v72
  v_fma_f32 v58, v58, s54, -v72
  v_fma_f32 v59, v59, s54, -v72
  v_exp_f32 v64, v64
  buffer_load_dwordx4 v[16:19], v0, s[4:7], s23 offen offset:0 sc1
  v_exp_f32 v65, v65
  v_exp_f32 v66, v66
  v_exp_f32 v67, v67
  v_exp_f32 v60, v60
  buffer_load_dwordx4 v[20:23], v0, s[4:7], s23 offen offset:1024 sc1
  v_exp_f32 v61, v61
  v_exp_f32 v62, v62
  v_exp_f32 v63, v63
  v_exp_f32 v56, v56
  buffer_load_dwordx4 v[32:35], v0, s[4:7], s25 offen offset:0 sc1
  v_exp_f32 v57, v57
  v_exp_f32 v58, v58
  v_exp_f32 v59, v59
  v_cvt_pk_bf16_f32 v70, v64, v65
  v_cvt_pk_bf16_f32 v71, v66, v67
  v_cvt_pk_bf16_f32 v68, v60, v61
  v_cvt_pk_bf16_f32 v69, v62, v63
  v_cvt_pk_bf16_f32 v74, v56, v57
  v_cvt_pk_bf16_f32 v75, v58, v59
  buffer_load_dwordx4 v[36:39], v0, s[4:7], s25 offen offset:1024 sc1
  v_mov_b32 v64, 0x3f803f80
  v_mov_b32 v65, 0x3f803f80
  v_mov_b32 v66, 0x3f803f80
  v_mov_b32 v67, 0x3f803f80
  v_mov_b64 v[72:73], 0
  s_waitcnt lgkmcnt(2)
  v_mfma_f32_16x16x32_bf16 v[56:59], v[40:43], v[68:71], 0
  v_mov_b32_dpp v72, v64 quad_perm:[0,1,2,3] row_mask:0x3 bank_mask:0xf
  v_mov_b32_dpp v73, v64 quad_perm:[0,1,2,3] row_mask:0x3 bank_mask:0xf
  v_mfma_f32_16x16x32_bf16 v[60:63], v[44:47], v[68:71], 0
  buffer_load_dwordx4 v0, s[4:7], s48 offen offset:0 sc1 nt lds
  v_mfma_f32_16x16x32_bf16 v[40:43], v[64:67], v[68:71], 0
  buffer_load_dwordx4 v0, s[4:7], s48 offen offset:1024 sc1 nt lds
  s_mov_b64 exec, 1
  buffer_load_dword v4, v0, s[4:7], s62 offen sc1
  s_mov_b64 exec, -1
  v_mfma_f32_16x16x16_bf16 v[56:59], v[76:77], v[74:75], v[56:59]
  s_mov_b32 m0, s27
  s_lshl_b32 s57, s34, 6
  v_mfma_f32_16x16x16_bf16 v[60:63], v[78:79], v[74:75], v[60:63]
  s_add_u32 s49, s49, 262144
  v_mfma_f32_16x16x16_bf16 v[40:43], v[72:73], v[74:75], v[40:43]
  v_xor_b32 v73, s57, v6
  s_nop 6
  v_rcp_f32 v72, v40
  s_nop 0
  v_mul_f32 v56, v56, v72
  v_mul_f32 v60, v60, v72
  v_mul_f32 v57, v57, v72
  v_mul_f32 v61, v61, v72
  v_mul_f32 v58, v58, v72
  v_mul_f32 v62, v62, v72
  v_mul_f32 v59, v59, v72
  v_mul_f32 v63, v63, v72
  v_cvt_pk_bf16_f32 v68, v56, v60
  v_cvt_pk_bf16_f32 v69, v57, v61
  v_cvt_pk_bf16_f32 v70, v58, v62
  v_cvt_pk_bf16_f32 v71, v59, v63
  ds_write_b128 v73, v[68:71]
  ds_read_b128 v[40:43], v7 offset:32768
  ds_read_b128 v[44:47], v7 offset:33792
  v_xor_b32 v64, 64, v6
  v_xor_b32 v65, 128, v6
  v_xor_b32 v66, 192, v6
  v_mov_b64 v[72:73], 0
  v_mov_b64 v[74:75], 0
  s_waitcnt lgkmcnt(2)
  v_mov_b64 v[68:69], 0
  v_mov_b64 v[70:71], 0
  s_barrier
  ds_read_b128 v[56:59], v6
  ds_read_b128 v[60:63], v64
  ds_read_b128 v[76:79], v65
  ds_read_b128 v[64:67], v66
  s_waitcnt lgkmcnt(3)
  v_smfmac_f32_16x16x64_bf16 v[68:71], v[56:59], a[168:175], v5
  s_waitcnt lgkmcnt(2)
  v_smfmac_f32_16x16x64_bf16 v[68:71], v[60:63], a[176:183], v5
  s_waitcnt lgkmcnt(1)
  v_smfmac_f32_16x16x64_bf16 v[68:71], v[76:79], a[184:191], v5
  s_waitcnt lgkmcnt(0)
  v_smfmac_f32_16x16x64_bf16 v[68:71], v[64:67], v[48:55], v5
  ds_read_b128 v[48:51], v7 offset:40960
  v_smfmac_f32_16x16x64_bf16 v[72:75], v[56:59], a[192:199], v5
  ds_read_b128 v[52:55], v7 offset:41984
  v_smfmac_f32_16x16x64_bf16 v[72:75], v[60:63], a[200:207], v5
  v_cvt_pk_bf16_f32 v68, v68, v69
  v_cvt_pk_bf16_f32 v69, v70, v71
  v_smfmac_f32_16x16x64_bf16 v[72:75], v[76:79], a[208:215], v5
  v_mov_b64 v[70:71], 0
  v_bfi_b32 v68, 1, s80, v68
  v_smfmac_f32_16x16x64_bf16 v[72:75], v[64:67], v[40:47], v5
  ds_read_b128 v[40:43], v7 offset:49152
  ds_read_b128 v[44:47], v7 offset:50176
  buffer_store_dwordx2 v[68:69], v3, s[4:7], s38 offen offset:0
  v_mov_b64 v[68:69], 0
  s_nop 1
  v_smfmac_f32_16x16x64_bf16 v[68:71], v[56:59], a[216:223], v5
  v_smfmac_f32_16x16x64_bf16 v[68:71], v[60:63], a[224:231], v5
  v_cvt_pk_bf16_f32 v72, v72, v73
  v_cvt_pk_bf16_f32 v73, v74, v75
  v_smfmac_f32_16x16x64_bf16 v[68:71], v[76:79], a[232:239], v5
  v_mov_b64 v[74:75], 0
  v_bfi_b32 v72, 1, s80, v72
  s_waitcnt lgkmcnt(2)
  v_smfmac_f32_16x16x64_bf16 v[68:71], v[64:67], v[48:55], v5
  ds_read_b128 v[48:51], v7 offset:57344
  ds_read_b128 v[52:55], v7 offset:58368
  buffer_store_dwordx2 v[72:73], v3, s[4:7], s38 offen offset:2048
  v_mov_b64 v[72:73], 0
  s_nop 1
  v_smfmac_f32_16x16x64_bf16 v[72:75], v[56:59], a[240:247], v5
  v_smfmac_f32_16x16x64_bf16 v[72:75], v[60:63], a[248:255], v5
  v_cvt_pk_bf16_f32 v68, v68, v69
  v_cvt_pk_bf16_f32 v69, v70, v71
  s_waitcnt vmcnt(5)
  v_smfmac_f32_16x16x64_bf16 v[72:75], v[76:79], v[32:39], v5
  v_mov_b64 v[70:71], 0
  v_bfi_b32 v68, 1, s80, v68
  s_waitcnt lgkmcnt(2)
  v_smfmac_f32_16x16x64_bf16 v[72:75], v[64:67], v[40:47], v5
  buffer_store_dwordx2 v[68:69], v3, s[4:7], s39 offen offset:0
  v_mov_b64 v[68:69], 0
  s_nop 1
  v_smfmac_f32_16x16x64_bf16 v[68:71], v[56:59], v[8:15], v5
  v_smfmac_f32_16x16x64_bf16 v[68:71], v[60:63], v[16:23], v5
  v_cvt_pk_bf16_f32 v72, v72, v73
  v_cvt_pk_bf16_f32 v73, v74, v75
  v_smfmac_f32_16x16x64_bf16 v[68:71], v[76:79], v[24:31], v5
  v_bfi_b32 v72, 1, s80, v72
  buffer_store_dwordx2 v[72:73], v3, s[4:7], s39 offen offset:2048
  s_waitcnt lgkmcnt(0)
  v_smfmac_f32_16x16x64_bf16 v[68:71], v[64:67], v[48:55], v5
  v_subrev_u32 v7, 0x10000, v7
  s_add_u32 s50, s50, 131072
  s_nop 3
  v_cvt_pk_bf16_f32 v68, v68, v69
  v_cvt_pk_bf16_f32 v69, v70, v71
  v_bfi_b32 v68, 1, s80, v68
  buffer_store_dwordx2 v[68:69], v3, s[4:7], s40 offen offset:0
  s_cmp_eq_u32 s37, 0
  s_cbranch_scc1 Lch_nored
  v_lshrrev_b32 v76, 4, v0
  v_and_b32 v72, 15, v76
  v_and_b32 v73, 1, v72
  v_lshlrev_b32 v73, 4, v73
  v_mov_b32 v74, 0x3f80
  v_lshlrev_b32 v73, v73, v74
  v_lshrrev_b32 v74, 1, v72
  v_cmp_eq_u32 vcc, 0, v74
  s_nop 1
  v_cndmask_b32 v68, 0, v73, vcc
  v_cmp_eq_u32 vcc, 1, v74
  s_nop 1
  v_cndmask_b32 v69, 0, v73, vcc
  v_cmp_eq_u32 vcc, 2, v74
  s_nop 1
  v_cndmask_b32 v70, 0, v73, vcc
  v_cmp_eq_u32 vcc, 3, v74
  s_nop 1
  v_cndmask_b32 v71, 0, v73, vcc
  s_mov_b32 s12, s47
  s_sub_u32 s11, s80, 1
  v_and_b32 v73, 3, v72
  v_lshlrev_b32 v73, 5, v73
  v_lshrrev_b32 v74, 4, v76
  v_and_b32 v74, 1, v74
  v_lshl_add_u32 v73, v74, 4, v73
  v_lshrrev_b32 v74, 2, v72
  v_lshlrev_b32 v74, 1, v74
  v_lshrrev_b32 v75, 5, v76
  v_add_u32 v74, v74, v75
  v_lshl_add_u32 v73, v74, 2, v73
  v_mov_b32 v74, 0x40000000
  v_cmp_gt_u32 vcc, 8, v72
  s_nop 1
  v_cndmask_b32 v78, v74, v73, vcc
  buffer_load_dwordx4 v[24:27], v1, s[4:7], s41 offen sc1
  buffer_load_dwordx4 v[28:31], v1, s[4:7], s42 offen sc1
  buffer_load_dwordx4 v[32:35], v1, s[4:7], s43 offen sc1
  buffer_load_dwordx4 v[36:39], v1, s[4:7], s44 offen sc1
  v_lshrrev_b32 v56, 4, v0
  v_lshrrev_b32 v57, 3, v56
  v_and_b32 v57, 3, v57
  v_and_b32 v58, 1, v57
  v_and_b32 v59, 7, v56
  v_lshrrev_b32 v59, 1, v59
  v_lshl_add_u32 v59, v58, 2, v59
  v_lshlrev_b32 v59, 6, v59
  v_and_b32 v60, 2, v57
  v_and_b32 v61, 1, v56
  v_add_u32 v60, v60, v61
  v_lshlrev_b32 v58, 1, v58
  v_xor_b32 v60, v60, v58
  v_lshl_add_u32 v59, v60, 4, v59
  s_lshl_b32 s57, s34, 11
  v_add_u32 v57, s57, v59
  v_lshrrev_b32 v56, 5, v56
  v_lshl_add_u32 v56, v56, 9, v57
  s_lshl_b32 s57, s34, 9
  s_add_u32 s57, s57, 8192
  v_add_u32 v57, s57, v59
  v_and_b32 v62, 0x1ff, v0
  s_mov_b32 s13, s46
  s_mov_b32 s14, s45
  s_mul_i32 s15, s34, 1536
  s_sub_u32 s15, s14, s15
  s_add_u32 s15, s15, 8192
  s_add_u32 s35, s35, 1
  s_add_u32 s80, s35, 1
  s_and_b32 s80, s80, 1
  s_lshl_b32 s58, s36, 7
  s_add_u32 s57, s35, 1
  s_and_b32 s57, s57, 3
  s_mul_i32 s57, s57, 10240
  s_add_u32 s57, s57, s53
  s_add_u32 s46, s57, s58
  s_lshl_b32 s59, s34, 11
  s_add_u32 s45, s57, s59
  s_add_u32 s57, s35, 3
  s_and_b32 s57, s57, 3
  s_mul_i32 s57, s57, 10240
  s_add_u32 s57, s57, s53
  s_add_u32 s47, s57, s58
  buffer_load_dwordx4 v[40:43], v1, s[4:7], s41 offen sc1
  buffer_load_dwordx4 v[44:47], v1, s[4:7], s42 offen sc1
  buffer_load_dwordx4 v[48:51], v1, s[4:7], s43 offen sc1
  buffer_load_dwordx4 v[52:55], v1, s[4:7], s44 offen sc1
Lch_rs:
  s_waitcnt vmcnt(4)
  v_bitop3_b32 v76, v24, v26, s11 bitop3:0x42
  v_mfma_f32_16x16x32_bf16 v[72:75], v[24:27], v[68:71], 0
  v_bitop3_b32 v77, v28, v30, s11 bitop3:0x42
  v_bitop3_b32 v79, v32, v34, s11 bitop3:0x42
  v_mfma_f32_16x16x32_bf16 v[72:75], v[28:31], v[68:71], v[72:75]
  v_bitop3_b32 v76, v76, v77, v79 bitop3:0x80
  v_bitop3_b32 v77, v36, v38, s11 bitop3:0x42
  v_mfma_f32_16x16x32_bf16 v[72:75], v[32:35], v[68:71], v[72:75]
  v_bitop3_b32 v76, v76, v77, 1 bitop3:0x80
  v_mfma_f32_16x16x32_bf16 v[72:75], v[36:39], v[68:71], v[72:75]
  v_cmp_eq_u32 vcc, 0, v76
  s_cbranch_vccz Lch_rsok
  buffer_load_dwordx4 v[24:27], v1, s[4:7], s41 offen sc1
  buffer_load_dwordx4 v[28:31], v1, s[4:7], s42 offen sc1
  buffer_load_dwordx4 v[32:35], v1, s[4:7], s43 offen sc1
  buffer_load_dwordx4 v[36:39], v1, s[4:7], s44 offen sc1
  s_waitcnt vmcnt(4)
  v_bitop3_b32 v76, v40, v42, s11 bitop3:0x42
  v_mfma_f32_16x16x32_bf16 v[72:75], v[40:43], v[68:71], 0
  v_bitop3_b32 v77, v44, v46, s11 bitop3:0x42
  v_bitop3_b32 v79, v48, v50, s11 bitop3:0x42
  v_mfma_f32_16x16x32_bf16 v[72:75], v[44:47], v[68:71], v[72:75]
  v_bitop3_b32 v76, v76, v77, v79 bitop3:0x80
  v_bitop3_b32 v77, v52, v54, s11 bitop3:0x42
  v_mfma_f32_16x16x32_bf16 v[72:75], v[48:51], v[68:71], v[72:75]
  v_bitop3_b32 v76, v76, v77, 1 bitop3:0x80
  v_mfma_f32_16x16x32_bf16 v[72:75], v[52:55], v[68:71], v[72:75]
  v_cmp_eq_u32 vcc, 0, v76
  s_cbranch_vccz Lch_rsok
  buffer_load_dwordx4 v[40:43], v1, s[4:7], s41 offen sc1
  buffer_load_dwordx4 v[44:47], v1, s[4:7], s42 offen sc1
  buffer_load_dwordx4 v[48:51], v1, s[4:7], s43 offen sc1
  buffer_load_dwordx4 v[52:55], v1, s[4:7], s44 offen sc1
  s_cmp_lg_u32 s56, 0
  s_cbranch_scc1 Lch_rsok
  s_sub_u32 s55, s55, 1
  s_cbranch_scc0 Lch_rs
  s_mov_b32 s56, 1
Lch_rsok:
  v_mov_b32 v68, -1
  s_nop 3
  v_permlane32_swap_b32 v72, v73
  v_permlane32_swap_b32 v74, v75
  v_add_f32 v72, v72, v73
  v_add_f32 v74, v74, v75
  v_cvt_pk_bf16_f32 v72, v72, v74
  buffer_store_dword v72, v78, s[4:7], s13 offen
  buffer_store_dword v68, v78, s[4:7], s12 offen
  s_branch Lch_agpre
Lch_nored:
  v_lshrrev_b32 v56, 4, v0
  v_lshrrev_b32 v57, 3, v56
  v_and_b32 v57, 3, v57
  v_and_b32 v58, 1, v57
  v_and_b32 v59, 7, v56
  v_lshrrev_b32 v59, 1, v59
  v_lshl_add_u32 v59, v58, 2, v59
  v_lshlrev_b32 v59, 6, v59
  v_and_b32 v60, 2, v57
  v_and_b32 v61, 1, v56
  v_add_u32 v60, v60, v61
  v_lshlrev_b32 v58, 1, v58
  v_xor_b32 v60, v60, v58
  v_lshl_add_u32 v59, v60, 4, v59
  s_lshl_b32 s57, s34, 11
  v_add_u32 v57, s57, v59
  v_lshrrev_b32 v56, 5, v56
  v_lshl_add_u32 v56, v56, 9, v57
  s_lshl_b32 s57, s34, 9
  s_add_u32 s57, s57, 8192
  v_add_u32 v57, s57, v59
  v_and_b32 v62, 0x1ff, v0
  s_mov_b32 s13, s46
  s_mov_b32 s14, s45
  s_mul_i32 s15, s34, 1536
  s_sub_u32 s15, s14, s15
  s_add_u32 s15, s15, 8192
  s_add_u32 s35, s35, 1
  s_add_u32 s80, s35, 1
  s_and_b32 s80, s80, 1
  s_lshl_b32 s58, s36, 7
  s_add_u32 s57, s35, 1
  s_and_b32 s57, s57, 3
  s_mul_i32 s57, s57, 10240
  s_add_u32 s57, s57, s53
  s_add_u32 s46, s57, s58
  s_lshl_b32 s59, s34, 11
  s_add_u32 s45, s57, s59
  s_add_u32 s57, s35, 3
  s_and_b32 s57, s57, 3
  s_mul_i32 s57, s57, 10240
  s_add_u32 s57, s57, s53
  s_add_u32 s47, s57, s58
  s_cmp_eq_u32 s34, 2
  s_cbranch_scc0 Lch_nonrs
  s_sleep 13
Lch_nonrs:
Lch_agpre:
  buffer_load_dwordx4 v[8:11], v0, s[4:7], s16 offen offset:0 sc1
  buffer_load_dwordx4 v[12:15], v0, s[4:7], s16 offen offset:1024 sc1
  buffer_load_dwordx4 v[16:19], v0, s[4:7], s17 offen offset:0 sc1
  buffer_load_dwordx4 v[20:23], v0, s[4:7], s17 offen offset:1024 sc1
  s_barrier
  buffer_load_dwordx4 v[24:27], v0, s[4:7], s14 offen sc1
  buffer_load_dwordx4 v[28:31], v0, s[4:7], s14 offen offset:1024 sc1
  buffer_load_dwordx4 v[32:35], v62, s[4:7], s15 offen sc1
  v_mov_b64 v[68:69], 0
  v_mov_b64 v[70:71], 0
  v_mov_b64 v[72:73], 0
  v_mov_b64 v[74:75], 0
  v_mov_b64 v[76:77], 0
  v_mov_b64 v[78:79], 0
  buffer_load_dwordx4 v[36:39], v62, s[4:7], s15 offen sc1
  s_waitcnt vmcnt(2)
  v_readfirstlane_b32 s60, v4
  v_writelane_b32 v4, 0, 0
Lch_age:
  v_max3_u32 v60, v24, v25, v26
  v_max3_u32 v61, v27, v28, v29
  v_max3_u32 v60, v60, v30, v31
  v_max_u32 v60, v60, v61
  v_cmp_eq_u32 vcc, -1, v60
  s_cbranch_vccz Lch_ageok
  s_cmp_lg_u32 s56, 0
  s_cbranch_scc1 Lch_ageok
  s_sub_u32 s55, s55, 1
  s_cbranch_scc1 Lch_ageab
  buffer_load_dwordx4 v[24:27], v0, s[4:7], s14 offen sc1
  buffer_load_dwordx4 v[28:31], v0, s[4:7], s14 offen offset:1024 sc1
  s_waitcnt vmcnt(0)
  s_branch Lch_age
Lch_ageab:
  s_mov_b32 s56, 1
Lch_ageok:
  ds_write_b128 v56, v[24:27] offset:0
  ds_write_b128 v56, v[28:31] offset:1024
  s_waitcnt vmcnt(1)
Lch_ag:
  v_max3_u32 v60, v32, v33, v34
  v_max_u32 v60, v60, v35
  v_cmp_eq_u32 vcc, -1, v60
  s_cbranch_vccz Lch_agokA
  buffer_load_dwordx4 v[32:35], v62, s[4:7], s15 offen sc1
  s_waitcnt vmcnt(1)
  v_max3_u32 v60, v36, v37, v38
  v_max_u32 v60, v60, v39
  v_cmp_eq_u32 vcc, -1, v60
  s_cbranch_vccz Lch_agokB
  buffer_load_dwordx4 v[36:39], v62, s[4:7], s15 offen sc1
  s_waitcnt vmcnt(1)
  s_cmp_lg_u32 s56, 0
  s_cbranch_scc1 Lch_agokB
  s_sub_u32 s55, s55, 1
  s_cbranch_scc0 Lch_ag
  s_mov_b32 s56, 1
Lch_agokB:
  ds_write_b128 v57, v[36:39] offset:0
  s_branch Lch_agdone
Lch_agokA:
  ds_write_b128 v57, v[32:35] offset:0
Lch_agdone:
  ds_read_b128 v[40:43], v7 offset:0
  ds_read_b128 v[44:47], v7 offset:1024
  ds_read_b128 v[48:51], v7 offset:8192
  ds_read_b128 v[52:55], v7 offset:9216
  s_waitcnt lgkmcnt(4)
  s_branch Lch_step
Lch_last:
  s_nop 1
  buffer_store_dwordx2 v[76:77], v3, s[4:7], s50 offen offset:2048 sc1
  s_waitcnt vmcnt(0) lgkmcnt(0)
  v_cmp_eq_u32 vcc, 0, v0
  v_mov_b32 v9, 0x40000000
  s_nop 0
  v_cndmask_b32 v9, v9, v0, vcc
  buffer_atomic_inc v5, v9, s[4:7], s63 offen sc1
  s_waitcnt vmcnt(0)
  s_endpgm
Lrole_g1:
  s_cmp_eq_u32 s32, 0
  s_cselect_b32 s8, s68, s82
  s_cselect_b32 s9, s69, s83
  s_cselect_b32 s12, s70, s84
  s_cselect_b32 s13, s71, s85
  s_cselect_b32 s16, s72, s86
  s_cselect_b32 s17, s73, s87
  s_cselect_b32 s20, s74, s88
  s_cselect_b32 s21, s75, s89
  s_cselect_b32 s24, s64, s78
  s_cselect_b32 s25, s65, s79
  s_and_b32 s9, s9, 0xffff
  s_mov_b32 s10, 5242880
  s_mov_b32 s11, 0x20000
  s_and_b32 s13, s13, 0xffff
  s_mov_b32 s14, 5242880
  s_mov_b32 s15, 0x20000
  s_and_b32 s17, s17, 0xffff
  s_mov_b32 s18, 5242880
  s_mov_b32 s19, 0x20000
  s_and_b32 s21, s21, 0xffff
  s_mov_b32 s22, 5242880
  s_mov_b32 s23, 0x20000
  s_and_b32 s25, s25, 0xffff
  s_mov_b32 s26, 2621440
  s_mov_b32 s27, 0x20000
  s_mov_b32 s48, s92
  s_mov_b32 s49, s93
  s_mov_b32 s90, s98
  v_lshrrev_b32 v8, 6, v0
  s_nop 0
  v_readfirstlane_b32 s34, v8
  s_mov_b32 s55, 0x40000
  s_mov_b32 s56, 0
  s_nop 2
  s_lshl_b32 s57, s32, 5
  s_add_u32 s57, s57, s33
  s_lshl_b32 s57, s57, 7
  s_add_u32 s36, s57, 0
  v_and_b32 v8, 63, v0
  v_mov_b32 v9, 0x40000000
  v_mov_b32 v10, 0
  v_cmp_eq_u32 vcc, 0, v8
  s_nop 1
  v_cndmask_b32 v9, v9, v10, vcc
  buffer_store_dword v10, v9, s[4:7], s36 offen sc1
  s_waitcnt vmcnt(0)
  s_barrier
  s_cmp_lg_u32 s34, 0
  s_cbranch_scc1 Lskip_arr0
  v_mov_b32 v10, 1
  buffer_atomic_add v10, v9, s[28:31], 0 offen offset:64
Lskip_arr0:
  v_and_b32 v20, 63, v0
  v_lshrrev_b32 v21, 4, v20
  v_and_b32 v22, 15, v20
  v_lshrrev_b32 v23, 2, v22
  v_and_b32 v24, 3, v22
  v_lshrrev_b32 v25, 1, v21
  v_lshl_add_u32 v23, v25, 3, v23
  v_lshlrev_b32 v23, 8, v23
  v_and_b32 v25, 1, v21
  v_lshl_add_u32 v23, v25, 5, v23
  v_lshl_add_u32 v23, v24, 3, v23
  s_lshl_b32 s57, s34, 6
  s_add_u32 s57, s57, 81920
  v_add_u32 v60, s57, v23
  v_lshlrev_b32 v23, 4, v22
  v_lshl_add_u32 v61, v21, 13, v23
  s_lshl_b32 s58, s33, 8
  s_lshl_b32 s57, s34, 16
  s_add_u32 s57, s57, s58
  s_add_u32 s57, s57, 0
  s_lshl_b32 s61, s34, 11
  s_add_u32 m0, s61, 81920
  s_nop 0
  buffer_load_dwordx4 v61, s[12:15], s57 offen nt lds
  s_lshl_b32 s57, s34, 16
  s_add_u32 s57, s57, s58
  s_add_u32 s57, s57, 32768
  s_lshl_b32 s61, s34, 11
  s_add_u32 m0, s61, 82944
  s_nop 0
  buffer_load_dwordx4 v61, s[12:15], s57 offen nt lds
  s_lshl_b32 s57, s34, 16
  s_add_u32 s57, s57, s58
  s_add_u32 s57, s57, 262144
  s_lshl_b32 s61, s34, 11
  s_add_u32 m0, s61, 90112
  s_nop 0
  buffer_load_dwordx4 v61, s[12:15], s57 offen nt lds
  s_lshl_b32 s57, s34, 16
  s_add_u32 s57, s57, s58
  s_add_u32 s57, s57, 294912
  s_lshl_b32 s61, s34, 11
  s_add_u32 m0, s61, 91136
  s_nop 0
  buffer_load_dwordx4 v61, s[12:15], s57 offen nt lds
  s_lshl_b32 s57, s34, 16
  s_add_u32 s57, s57, s58
  s_add_u32 s57, s57, 524288
  s_lshl_b32 s61, s34, 11
  s_add_u32 m0, s61, 98304
  s_nop 0
  buffer_load_dwordx4 v61, s[12:15], s57 offen nt lds
  s_lshl_b32 s57, s34, 16
  s_add_u32 s57, s57, s58
  s_add_u32 s57, s57, 557056
  s_lshl_b32 s61, s34, 11
  s_add_u32 m0, s61, 99328
  s_nop 0
  buffer_load_dwordx4 v61, s[12:15], s57 offen nt lds
  s_lshl_b32 s57, s34, 16
  s_add_u32 s57, s57, s58
  s_add_u32 s57, s57, 786432
  s_lshl_b32 s61, s34, 11
  s_add_u32 m0, s61, 106496
  s_nop 0
  buffer_load_dwordx4 v61, s[12:15], s57 offen nt lds
  s_lshl_b32 s57, s34, 16
  s_add_u32 s57, s57, s58
  s_add_u32 s57, s57, 819200
  s_lshl_b32 s61, s34, 11
  s_add_u32 m0, s61, 107520
  s_nop 0
  buffer_load_dwordx4 v61, s[12:15], s57 offen nt lds
  s_lshl_b32 s57, s34, 16
  s_add_u32 s57, s57, s58
  s_add_u32 s57, s57, 1048576
  s_lshl_b32 s61, s34, 11
  s_add_u32 m0, s61, 114688
  s_nop 0
  buffer_load_dwordx4 v61, s[12:15], s57 offen nt lds
  s_lshl_b32 s57, s34, 16
  s_add_u32 s57, s57, s58
  s_add_u32 s57, s57, 1081344
  s_lshl_b32 s61, s34, 11
  s_add_u32 m0, s61, 115712
  s_nop 0
  buffer_load_dwordx4 v61, s[12:15], s57 offen nt lds
  s_lshl_b32 s57, s34, 16
  s_add_u32 s57, s57, s58
  s_add_u32 s57, s57, 1310720
  s_lshl_b32 s61, s34, 11
  s_add_u32 m0, s61, 122880
  s_nop 0
  buffer_load_dwordx4 v61, s[12:15], s57 offen nt lds
  s_lshl_b32 s57, s34, 16
  s_add_u32 s57, s57, s58
  s_add_u32 s57, s57, 1343488
  s_lshl_b32 s61, s34, 11
  s_add_u32 m0, s61, 123904
  s_nop 0
  buffer_load_dwordx4 v61, s[12:15], s57 offen nt lds
  s_lshl_b32 s57, s34, 16
  s_add_u32 s57, s57, s58
  s_add_u32 s57, s57, 1572864
  s_lshl_b32 s61, s34, 11
  s_add_u32 m0, s61, 131072
  s_nop 0
  buffer_load_dwordx4 v61, s[12:15], s57 offen nt lds
  s_lshl_b32 s57, s34, 16
  s_add_u32 s57, s57, s58
  s_add_u32 s57, s57, 1605632
  s_lshl_b32 s61, s34, 11
  s_add_u32 m0, s61, 132096
  s_nop 0
  buffer_load_dwordx4 v61, s[12:15], s57 offen nt lds
  s_lshl_b32 s57, s34, 16
  s_add_u32 s57, s57, s58
  s_add_u32 s57, s57, 1835008
  s_lshl_b32 s61, s34, 11
  s_add_u32 m0, s61, 139264
  s_nop 0
  buffer_load_dwordx4 v61, s[12:15], s57 offen nt lds
  s_lshl_b32 s57, s34, 16
  s_add_u32 s57, s57, s58
  s_add_u32 s57, s57, 1867776
  s_lshl_b32 s61, s34, 11
  s_add_u32 m0, s61, 140288
  s_nop 0
  buffer_load_dwordx4 v61, s[12:15], s57 offen nt lds
  s_waitcnt vmcnt(14)
  s_barrier
  ds_read_b64_tr_b16 v[96:97], v60 offset:0
  ds_read_b64_tr_b16 v[98:99], v60 offset:1024
  ds_read_b64_tr_b16 v[100:101], v60 offset:4096
  ds_read_b64_tr_b16 v[102:103], v60 offset:5120
  s_waitcnt lgkmcnt(0)
  s_waitcnt vmcnt(12)
  s_barrier
  s_lshl_b32 s57, s34, 16
  s_add_u32 s57, s57, s58
  s_add_u32 s57, s57, 2097152
  s_lshl_b32 s61, s34, 11
  s_add_u32 m0, s61, 81920
  s_nop 0
  buffer_load_dwordx4 v61, s[12:15], s57 offen nt lds
  s_lshl_b32 s57, s34, 16
  s_add_u32 s57, s57, s58
  s_add_u32 s57, s57, 2129920
  s_lshl_b32 s61, s34, 11
  s_add_u32 m0, s61, 82944
  s_nop 0
  buffer_load_dwordx4 v61, s[12:15], s57 offen nt lds
  ds_read_b64_tr_b16 v[104:105], v60 offset:8192
  ds_read_b64_tr_b16 v[106:107], v60 offset:9216
  ds_read_b64_tr_b16 v[108:109], v60 offset:12288
  ds_read_b64_tr_b16 v[110:111], v60 offset:13312
  s_waitcnt lgkmcnt(0)
  s_waitcnt vmcnt(12)
  s_barrier
  s_lshl_b32 s57, s34, 16
  s_add_u32 s57, s57, s58
  s_add_u32 s57, s57, 2359296
  s_lshl_b32 s61, s34, 11
  s_add_u32 m0, s61, 90112
  s_nop 0
  buffer_load_dwordx4 v61, s[12:15], s57 offen nt lds
  s_lshl_b32 s57, s34, 16
  s_add_u32 s57, s57, s58
  s_add_u32 s57, s57, 2392064
  s_lshl_b32 s61, s34, 11
  s_add_u32 m0, s61, 91136
  s_nop 0
  buffer_load_dwordx4 v61, s[12:15], s57 offen nt lds
  ds_read_b64_tr_b16 v[112:113], v60 offset:16384
  ds_read_b64_tr_b16 v[114:115], v60 offset:17408
  ds_read_b64_tr_b16 v[116:117], v60 offset:20480
  ds_read_b64_tr_b16 v[118:119], v60 offset:21504
  s_waitcnt lgkmcnt(0)
  s_waitcnt vmcnt(12)
  s_barrier
  s_lshl_b32 s57, s34, 16
  s_add_u32 s57, s57, s58
  s_add_u32 s57, s57, 2621440
  s_lshl_b32 s61, s34, 11
  s_add_u32 m0, s61, 98304
  s_nop 0
  buffer_load_dwordx4 v61, s[12:15], s57 offen nt lds
  s_lshl_b32 s57, s34, 16
  s_add_u32 s57, s57, s58
  s_add_u32 s57, s57, 2654208
  s_lshl_b32 s61, s34, 11
  s_add_u32 m0, s61, 99328
  s_nop 0
  buffer_load_dwordx4 v61, s[12:15], s57 offen nt lds
  ds_read_b64_tr_b16 v[120:121], v60 offset:24576
  ds_read_b64_tr_b16 v[122:123], v60 offset:25600
  ds_read_b64_tr_b16 v[124:125], v60 offset:28672
  ds_read_b64_tr_b16 v[126:127], v60 offset:29696
  s_waitcnt lgkmcnt(0)
  s_waitcnt vmcnt(12)
  s_barrier
  s_lshl_b32 s57, s34, 16
  s_add_u32 s57, s57, s58
  s_add_u32 s57, s57, 2883584
  s_lshl_b32 s61, s34, 11
  s_add_u32 m0, s61, 106496
  s_nop 0
  buffer_load_dwordx4 v61, s[12:15], s57 offen nt lds
  s_lshl_b32 s57, s34, 16
  s_add_u32 s57, s57, s58
  s_add_u32 s57, s57, 2916352
  s_lshl_b32 s61, s34, 11
  s_add_u32 m0, s61, 107520
  s_nop 0
  buffer_load_dwordx4 v61, s[12:15], s57 offen nt lds
  ds_read_b64_tr_b16 v[128:129], v60 offset:32768
  ds_read_b64_tr_b16 v[130:131], v60 offset:33792
  ds_read_b64_tr_b16 v[132:133], v60 offset:36864
  ds_read_b64_tr_b16 v[134:135], v60 offset:37888
  s_waitcnt lgkmcnt(0)
  s_waitcnt vmcnt(12)
  s_barrier
  s_lshl_b32 s57, s34, 16
  s_add_u32 s57, s57, s58
  s_add_u32 s57, s57, 3145728
  s_lshl_b32 s61, s34, 11
  s_add_u32 m0, s61, 114688
  s_nop 0
  buffer_load_dwordx4 v61, s[12:15], s57 offen nt lds
  s_lshl_b32 s57, s34, 16
  s_add_u32 s57, s57, s58
  s_add_u32 s57, s57, 3178496
  s_lshl_b32 s61, s34, 11
  s_add_u32 m0, s61, 115712
  s_nop 0
  buffer_load_dwordx4 v61, s[12:15], s57 offen nt lds
  ds_read_b64_tr_b16 v[136:137], v60 offset:40960
  ds_read_b64_tr_b16 v[138:139], v60 offset:41984
  ds_read_b64_tr_b16 v[140:141], v60 offset:45056
  ds_read_b64_tr_b16 v[142:143], v60 offset:46080
  s_waitcnt lgkmcnt(0)
  s_waitcnt vmcnt(12)
  s_barrier
  s_lshl_b32 s57, s34, 16
  s_add_u32 s57, s57, s58
  s_add_u32 s57, s57, 3407872
  s_lshl_b32 s61, s34, 11
  s_add_u32 m0, s61, 122880
  s_nop 0
  buffer_load_dwordx4 v61, s[12:15], s57 offen nt lds
  s_lshl_b32 s57, s34, 16
  s_add_u32 s57, s57, s58
  s_add_u32 s57, s57, 3440640
  s_lshl_b32 s61, s34, 11
  s_add_u32 m0, s61, 123904
  s_nop 0
  buffer_load_dwordx4 v61, s[12:15], s57 offen nt lds
  ds_read_b64_tr_b16 v[144:145], v60 offset:49152
  ds_read_b64_tr_b16 v[146:147], v60 offset:50176
  ds_read_b64_tr_b16 v[148:149], v60 offset:53248
  ds_read_b64_tr_b16 v[150:151], v60 offset:54272
  s_waitcnt lgkmcnt(0)
  s_waitcnt vmcnt(12)
  s_barrier
  s_lshl_b32 s57, s34, 16
  s_add_u32 s57, s57, s58
  s_add_u32 s57, s57, 3670016
  s_lshl_b32 s61, s34, 11
  s_add_u32 m0, s61, 131072
  s_nop 0
  buffer_load_dwordx4 v61, s[12:15], s57 offen nt lds
  s_lshl_b32 s57, s34, 16
  s_add_u32 s57, s57, s58
  s_add_u32 s57, s57, 3702784
  s_lshl_b32 s61, s34, 11
  s_add_u32 m0, s61, 132096
  s_nop 0
  buffer_load_dwordx4 v61, s[12:15], s57 offen nt lds
  ds_read_b64_tr_b16 v[152:153], v60 offset:57344
  ds_read_b64_tr_b16 v[154:155], v60 offset:58368
  ds_read_b64_tr_b16 v[156:157], v60 offset:61440
  ds_read_b64_tr_b16 v[158:159], v60 offset:62464
  s_waitcnt lgkmcnt(0)
  s_waitcnt vmcnt(12)
  s_barrier
  s_lshl_b32 s57, s34, 16
  s_add_u32 s57, s57, s58
  s_add_u32 s57, s57, 3932160
  s_lshl_b32 s61, s34, 11
  s_add_u32 m0, s61, 139264
  s_nop 0
  buffer_load_dwordx4 v61, s[12:15], s57 offen nt lds
  s_lshl_b32 s57, s34, 16
  s_add_u32 s57, s57, s58
  s_add_u32 s57, s57, 3964928
  s_lshl_b32 s61, s34, 11
  s_add_u32 m0, s61, 140288
  s_nop 0
  buffer_load_dwordx4 v61, s[12:15], s57 offen nt lds
  ds_read_b64_tr_b16 v[160:161], v60 offset:0
  ds_read_b64_tr_b16 v[162:163], v60 offset:1024
  ds_read_b64_tr_b16 v[164:165], v60 offset:4096
  ds_read_b64_tr_b16 v[166:167], v60 offset:5120
  s_waitcnt lgkmcnt(0)
  s_waitcnt vmcnt(12)
  s_barrier
  s_lshl_b32 s57, s34, 16
  s_add_u32 s57, s57, s58
  s_add_u32 s57, s57, 4194304
  s_lshl_b32 s61, s34, 11
  s_add_u32 m0, s61, 81920
  s_nop 0
  buffer_load_dwordx4 v61, s[12:15], s57 offen nt lds
  s_lshl_b32 s57, s34, 16
  s_add_u32 s57, s57, s58
  s_add_u32 s57, s57, 4227072
  s_lshl_b32 s61, s34, 11
  s_add_u32 m0, s61, 82944
  s_nop 0
  buffer_load_dwordx4 v61, s[12:15], s57 offen nt lds
  ds_read_b64_tr_b16 v[168:169], v60 offset:8192
  ds_read_b64_tr_b16 v[170:171], v60 offset:9216
  ds_read_b64_tr_b16 v[172:173], v60 offset:12288
  ds_read_b64_tr_b16 v[174:175], v60 offset:13312
  s_waitcnt lgkmcnt(0)
  s_waitcnt vmcnt(12)
  s_barrier
  s_lshl_b32 s57, s34, 16
  s_add_u32 s57, s57, s58
  s_add_u32 s57, s57, 4456448
  s_lshl_b32 s61, s34, 11
  s_add_u32 m0, s61, 90112
  s_nop 0
  buffer_load_dwordx4 v61, s[12:15], s57 offen nt lds
  s_lshl_b32 s57, s34, 16
  s_add_u32 s57, s57, s58
  s_add_u32 s57, s57, 4489216
  s_lshl_b32 s61, s34, 11
  s_add_u32 m0, s61, 91136
  s_nop 0
  buffer_load_dwordx4 v61, s[12:15], s57 offen nt lds
  ds_read_b64_tr_b16 v[176:177], v60 offset:16384
  ds_read_b64_tr_b16 v[178:179], v60 offset:17408
  ds_read_b64_tr_b16 v[180:181], v60 offset:20480
  ds_read_b64_tr_b16 v[182:183], v60 offset:21504
  s_waitcnt lgkmcnt(0)
  s_waitcnt vmcnt(12)
  s_barrier
  s_lshl_b32 s57, s34, 16
  s_add_u32 s57, s57, s58
  s_add_u32 s57, s57, 4718592
  s_lshl_b32 s61, s34, 11
  s_add_u32 m0, s61, 98304
  s_nop 0
  buffer_load_dwordx4 v61, s[12:15], s57 offen nt lds
  s_lshl_b32 s57, s34, 16
  s_add_u32 s57, s57, s58
  s_add_u32 s57, s57, 4751360
  s_lshl_b32 s61, s34, 11
  s_add_u32 m0, s61, 99328
  s_nop 0
  buffer_load_dwordx4 v61, s[12:15], s57 offen nt lds
  ds_read_b64_tr_b16 v[184:185], v60 offset:24576
  ds_read_b64_tr_b16 v[186:187], v60 offset:25600
  ds_read_b64_tr_b16 v[188:189], v60 offset:28672
  ds_read_b64_tr_b16 v[190:191], v60 offset:29696
  s_waitcnt lgkmcnt(0)
  s_waitcnt vmcnt(12)
  s_barrier
  s_lshl_b32 s57, s34, 16
  s_add_u32 s57, s57, s58
  s_add_u32 s57, s57, 4980736
  s_lshl_b32 s61, s34, 11
  s_add_u32 m0, s61, 106496
  s_nop 0
  buffer_load_dwordx4 v61, s[12:15], s57 offen nt lds
  s_lshl_b32 s57, s34, 16
  s_add_u32 s57, s57, s58
  s_add_u32 s57, s57, 5013504
  s_lshl_b32 s61, s34, 11
  s_add_u32 m0, s61, 107520
  s_nop 0
  buffer_load_dwordx4 v61, s[12:15], s57 offen nt lds
  ds_read_b64_tr_b16 v[192:193], v60 offset:32768
  ds_read_b64_tr_b16 v[194:195], v60 offset:33792
  ds_read_b64_tr_b16 v[196:197], v60 offset:36864
  ds_read_b64_tr_b16 v[198:199], v60 offset:37888
  s_waitcnt lgkmcnt(0)
  s_waitcnt vmcnt(12)
  s_barrier
  ds_read_b64_tr_b16 v[200:201], v60 offset:40960
  ds_read_b64_tr_b16 v[202:203], v60 offset:41984
  ds_read_b64_tr_b16 v[204:205], v60 offset:45056
  ds_read_b64_tr_b16 v[206:207], v60 offset:46080
  s_waitcnt lgkmcnt(0)
  s_waitcnt vmcnt(10)
  s_barrier
  ds_read_b64_tr_b16 v[208:209], v60 offset:49152
  ds_read_b64_tr_b16 v[210:211], v60 offset:50176
  ds_read_b64_tr_b16 v[212:213], v60 offset:53248
  ds_read_b64_tr_b16 v[214:215], v60 offset:54272
  s_waitcnt lgkmcnt(0)
  s_waitcnt vmcnt(8)
  s_barrier
  ds_read_b64_tr_b16 v[216:217], v60 offset:57344
  ds_read_b64_tr_b16 v[218:219], v60 offset:58368
  ds_read_b64_tr_b16 v[220:221], v60 offset:61440
  ds_read_b64_tr_b16 v[222:223], v60 offset:62464
  s_waitcnt lgkmcnt(0)
  s_waitcnt vmcnt(6)
  s_barrier
  ds_read_b64_tr_b16 v[224:225], v60 offset:0
  ds_read_b64_tr_b16 v[226:227], v60 offset:1024
  ds_read_b64_tr_b16 v[228:229], v60 offset:4096
  ds_read_b64_tr_b16 v[230:231], v60 offset:5120
  s_waitcnt lgkmcnt(0)
  s_waitcnt vmcnt(4)
  s_barrier
  ds_read_b64_tr_b16 v[232:233], v60 offset:8192
  ds_read_b64_tr_b16 v[234:235], v60 offset:9216
  ds_read_b64_tr_b16 v[236:237], v60 offset:12288
  ds_read_b64_tr_b16 v[238:239], v60 offset:13312
  s_waitcnt lgkmcnt(0)
  s_waitcnt vmcnt(2)
  s_barrier
  ds_read_b64_tr_b16 v[240:241], v60 offset:16384
  ds_read_b64_tr_b16 v[242:243], v60 offset:17408
  ds_read_b64_tr_b16 v[244:245], v60 offset:20480
  ds_read_b64_tr_b16 v[246:247], v60 offset:21504
  s_waitcnt lgkmcnt(0)
  s_waitcnt vmcnt(0)
  s_barrier
  ds_read_b64_tr_b16 v[248:249], v60 offset:24576
  ds_read_b64_tr_b16 v[250:251], v60 offset:25600
  ds_read_b64_tr_b16 v[252:253], v60 offset:28672
  ds_read_b64_tr_b16 v[254:255], v60 offset:29696
  s_waitcnt lgkmcnt(0)
  s_barrier
  s_lshl_b32 s58, s33, 8
  s_lshl_b32 s57, s34, 16
  s_add_u32 s57, s57, s58
  s_add_u32 s57, s57, 0
  s_lshl_b32 s61, s34, 11
  s_add_u32 m0, s61, 81920
  s_nop 0
  buffer_load_dwordx4 v61, s[16:19], s57 offen nt lds
  s_lshl_b32 s57, s34, 16
  s_add_u32 s57, s57, s58
  s_add_u32 s57, s57, 32768
  s_lshl_b32 s61, s34, 11
  s_add_u32 m0, s61, 82944
  s_nop 0
  buffer_load_dwordx4 v61, s[16:19], s57 offen nt lds
  s_lshl_b32 s57, s34, 16
  s_add_u32 s57, s57, s58
  s_add_u32 s57, s57, 262144
  s_lshl_b32 s61, s34, 11
  s_add_u32 m0, s61, 90112
  s_nop 0
  buffer_load_dwordx4 v61, s[16:19], s57 offen nt lds
  s_lshl_b32 s57, s34, 16
  s_add_u32 s57, s57, s58
  s_add_u32 s57, s57, 294912
  s_lshl_b32 s61, s34, 11
  s_add_u32 m0, s61, 91136
  s_nop 0
  buffer_load_dwordx4 v61, s[16:19], s57 offen nt lds
  s_lshl_b32 s57, s34, 16
  s_add_u32 s57, s57, s58
  s_add_u32 s57, s57, 524288
  s_lshl_b32 s61, s34, 11
  s_add_u32 m0, s61, 98304
  s_nop 0
  buffer_load_dwordx4 v61, s[16:19], s57 offen nt lds
  s_lshl_b32 s57, s34, 16
  s_add_u32 s57, s57, s58
  s_add_u32 s57, s57, 557056
  s_lshl_b32 s61, s34, 11
  s_add_u32 m0, s61, 99328
  s_nop 0
  buffer_load_dwordx4 v61, s[16:19], s57 offen nt lds
  s_lshl_b32 s57, s34, 16
  s_add_u32 s57, s57, s58
  s_add_u32 s57, s57, 786432
  s_lshl_b32 s61, s34, 11
  s_add_u32 m0, s61, 106496
  s_nop 0
  buffer_load_dwordx4 v61, s[16:19], s57 offen nt lds
  s_lshl_b32 s57, s34, 16
  s_add_u32 s57, s57, s58
  s_add_u32 s57, s57, 819200
  s_lshl_b32 s61, s34, 11
  s_add_u32 m0, s61, 107520
  s_nop 0
  buffer_load_dwordx4 v61, s[16:19], s57 offen nt lds
  s_lshl_b32 s57, s34, 16
  s_add_u32 s57, s57, s58
  s_add_u32 s57, s57, 1048576
  s_lshl_b32 s61, s34, 11
  s_add_u32 m0, s61, 114688
  s_nop 0
  buffer_load_dwordx4 v61, s[16:19], s57 offen nt lds
  s_lshl_b32 s57, s34, 16
  s_add_u32 s57, s57, s58
  s_add_u32 s57, s57, 1081344
  s_lshl_b32 s61, s34, 11
  s_add_u32 m0, s61, 115712
  s_nop 0
  buffer_load_dwordx4 v61, s[16:19], s57 offen nt lds
  s_lshl_b32 s57, s34, 16
  s_add_u32 s57, s57, s58
  s_add_u32 s57, s57, 1310720
  s_lshl_b32 s61, s34, 11
  s_add_u32 m0, s61, 122880
  s_nop 0
  buffer_load_dwordx4 v61, s[16:19], s57 offen nt lds
  s_lshl_b32 s57, s34, 16
  s_add_u32 s57, s57, s58
  s_add_u32 s57, s57, 1343488
  s_lshl_b32 s61, s34, 11
  s_add_u32 m0, s61, 123904
  s_nop 0
  buffer_load_dwordx4 v61, s[16:19], s57 offen nt lds
  s_lshl_b32 s57, s34, 16
  s_add_u32 s57, s57, s58
  s_add_u32 s57, s57, 1572864
  s_lshl_b32 s61, s34, 11
  s_add_u32 m0, s61, 131072
  s_nop 0
  buffer_load_dwordx4 v61, s[16:19], s57 offen nt lds
  s_lshl_b32 s57, s34, 16
  s_add_u32 s57, s57, s58
  s_add_u32 s57, s57, 1605632
  s_lshl_b32 s61, s34, 11
  s_add_u32 m0, s61, 132096
  s_nop 0
  buffer_load_dwordx4 v61, s[16:19], s57 offen nt lds
  s_lshl_b32 s57, s34, 16
  s_add_u32 s57, s57, s58
  s_add_u32 s57, s57, 1835008
  s_lshl_b32 s61, s34, 11
  s_add_u32 m0, s61, 139264
  s_nop 0
  buffer_load_dwordx4 v61, s[16:19], s57 offen nt lds
  s_lshl_b32 s57, s34, 16
  s_add_u32 s57, s57, s58
  s_add_u32 s57, s57, 1867776
  s_lshl_b32 s61, s34, 11
  s_add_u32 m0, s61, 140288
  s_nop 0
  buffer_load_dwordx4 v61, s[16:19], s57 offen nt lds
  s_waitcnt vmcnt(14)
  s_barrier
  ds_read_b64_tr_b16 a[0:1], v60 offset:0
  ds_read_b64_tr_b16 a[2:3], v60 offset:1024
  ds_read_b64_tr_b16 a[4:5], v60 offset:4096
  ds_read_b64_tr_b16 a[6:7], v60 offset:5120
  s_waitcnt lgkmcnt(0)
  s_waitcnt vmcnt(12)
  s_barrier
  s_lshl_b32 s57, s34, 16
  s_add_u32 s57, s57, s58
  s_add_u32 s57, s57, 2097152
  s_lshl_b32 s61, s34, 11
  s_add_u32 m0, s61, 81920
  s_nop 0
  buffer_load_dwordx4 v61, s[16:19], s57 offen nt lds
  s_lshl_b32 s57, s34, 16
  s_add_u32 s57, s57, s58
  s_add_u32 s57, s57, 2129920
  s_lshl_b32 s61, s34, 11
  s_add_u32 m0, s61, 82944
  s_nop 0
  buffer_load_dwordx4 v61, s[16:19], s57 offen nt lds
  ds_read_b64_tr_b16 a[8:9], v60 offset:8192
  ds_read_b64_tr_b16 a[10:11], v60 offset:9216
  ds_read_b64_tr_b16 a[12:13], v60 offset:12288
  ds_read_b64_tr_b16 a[14:15], v60 offset:13312
  s_waitcnt lgkmcnt(0)
  s_waitcnt vmcnt(12)
  s_barrier
  s_lshl_b32 s57, s34, 16
  s_add_u32 s57, s57, s58
  s_add_u32 s57, s57, 2359296
  s_lshl_b32 s61, s34, 11
  s_add_u32 m0, s61, 90112
  s_nop 0
  buffer_load_dwordx4 v61, s[16:19], s57 offen nt lds
  s_lshl_b32 s57, s34, 16
  s_add_u32 s57, s57, s58
  s_add_u32 s57, s57, 2392064
  s_lshl_b32 s61, s34, 11
  s_add_u32 m0, s61, 91136
  s_nop 0
  buffer_load_dwordx4 v61, s[16:19], s57 offen nt lds
  ds_read_b64_tr_b16 a[16:17], v60 offset:16384
  ds_read_b64_tr_b16 a[18:19], v60 offset:17408
  ds_read_b64_tr_b16 a[20:21], v60 offset:20480
  ds_read_b64_tr_b16 a[22:23], v60 offset:21504
  s_waitcnt lgkmcnt(0)
  s_waitcnt vmcnt(12)
  s_barrier
  s_lshl_b32 s57, s34, 16
  s_add_u32 s57, s57, s58
  s_add_u32 s57, s57, 2621440
  s_lshl_b32 s61, s34, 11
  s_add_u32 m0, s61, 98304
  s_nop 0
  buffer_load_dwordx4 v61, s[16:19], s57 offen nt lds
  s_lshl_b32 s57, s34, 16
  s_add_u32 s57, s57, s58
  s_add_u32 s57, s57, 2654208
  s_lshl_b32 s61, s34, 11
  s_add_u32 m0, s61, 99328
  s_nop 0
  buffer_load_dwordx4 v61, s[16:19], s57 offen nt lds
  ds_read_b64_tr_b16 a[24:25], v60 offset:24576
  ds_read_b64_tr_b16 a[26:27], v60 offset:25600
  ds_read_b64_tr_b16 a[28:29], v60 offset:28672
  ds_read_b64_tr_b16 a[30:31], v60 offset:29696
  s_waitcnt lgkmcnt(0)
  s_waitcnt vmcnt(12)
  s_barrier
  s_lshl_b32 s57, s34, 16
  s_add_u32 s57, s57, s58
  s_add_u32 s57, s57, 2883584
  s_lshl_b32 s61, s34, 11
  s_add_u32 m0, s61, 106496
  s_nop 0
  buffer_load_dwordx4 v61, s[16:19], s57 offen nt lds
  s_lshl_b32 s57, s34, 16
  s_add_u32 s57, s57, s58
  s_add_u32 s57, s57, 2916352
  s_lshl_b32 s61, s34, 11
  s_add_u32 m0, s61, 107520
  s_nop 0
  buffer_load_dwordx4 v61, s[16:19], s57 offen nt lds
  ds_read_b64_tr_b16 a[32:33], v60 offset:32768
  ds_read_b64_tr_b16 a[34:35], v60 offset:33792
  ds_read_b64_tr_b16 a[36:37], v60 offset:36864
  ds_read_b64_tr_b16 a[38:39], v60 offset:37888
  s_waitcnt lgkmcnt(0)
  s_waitcnt vmcnt(12)
  s_barrier
  s_lshl_b32 s57, s34, 16
  s_add_u32 s57, s57, s58
  s_add_u32 s57, s57, 3145728
  s_lshl_b32 s61, s34, 11
  s_add_u32 m0, s61, 114688
  s_nop 0
  buffer_load_dwordx4 v61, s[16:19], s57 offen nt lds
  s_lshl_b32 s57, s34, 16
  s_add_u32 s57, s57, s58
  s_add_u32 s57, s57, 3178496
  s_lshl_b32 s61, s34, 11
  s_add_u32 m0, s61, 115712
  s_nop 0
  buffer_load_dwordx4 v61, s[16:19], s57 offen nt lds
  ds_read_b64_tr_b16 a[40:41], v60 offset:40960
  ds_read_b64_tr_b16 a[42:43], v60 offset:41984
  ds_read_b64_tr_b16 a[44:45], v60 offset:45056
  ds_read_b64_tr_b16 a[46:47], v60 offset:46080
  s_waitcnt lgkmcnt(0)
  s_waitcnt vmcnt(12)
  s_barrier
  s_lshl_b32 s57, s34, 16
  s_add_u32 s57, s57, s58
  s_add_u32 s57, s57, 3407872
  s_lshl_b32 s61, s34, 11
  s_add_u32 m0, s61, 122880
  s_nop 0
  buffer_load_dwordx4 v61, s[16:19], s57 offen nt lds
  s_lshl_b32 s57, s34, 16
  s_add_u32 s57, s57, s58
  s_add_u32 s57, s57, 3440640
  s_lshl_b32 s61, s34, 11
  s_add_u32 m0, s61, 123904
  s_nop 0
  buffer_load_dwordx4 v61, s[16:19], s57 offen nt lds
  ds_read_b64_tr_b16 a[48:49], v60 offset:49152
  ds_read_b64_tr_b16 a[50:51], v60 offset:50176
  ds_read_b64_tr_b16 a[52:53], v60 offset:53248
  ds_read_b64_tr_b16 a[54:55], v60 offset:54272
  s_waitcnt lgkmcnt(0)
  s_waitcnt vmcnt(12)
  s_barrier
  s_lshl_b32 s57, s34, 16
  s_add_u32 s57, s57, s58
  s_add_u32 s57, s57, 3670016
  s_lshl_b32 s61, s34, 11
  s_add_u32 m0, s61, 131072
  s_nop 0
  buffer_load_dwordx4 v61, s[16:19], s57 offen nt lds
  s_lshl_b32 s57, s34, 16
  s_add_u32 s57, s57, s58
  s_add_u32 s57, s57, 3702784
  s_lshl_b32 s61, s34, 11
  s_add_u32 m0, s61, 132096
  s_nop 0
  buffer_load_dwordx4 v61, s[16:19], s57 offen nt lds
  ds_read_b64_tr_b16 a[56:57], v60 offset:57344
  ds_read_b64_tr_b16 a[58:59], v60 offset:58368
  ds_read_b64_tr_b16 a[60:61], v60 offset:61440
  ds_read_b64_tr_b16 a[62:63], v60 offset:62464
  s_waitcnt lgkmcnt(0)
  s_waitcnt vmcnt(12)
  s_barrier
  s_lshl_b32 s57, s34, 16
  s_add_u32 s57, s57, s58
  s_add_u32 s57, s57, 3932160
  s_lshl_b32 s61, s34, 11
  s_add_u32 m0, s61, 139264
  s_nop 0
  buffer_load_dwordx4 v61, s[16:19], s57 offen nt lds
  s_lshl_b32 s57, s34, 16
  s_add_u32 s57, s57, s58
  s_add_u32 s57, s57, 3964928
  s_lshl_b32 s61, s34, 11
  s_add_u32 m0, s61, 140288
  s_nop 0
  buffer_load_dwordx4 v61, s[16:19], s57 offen nt lds
  ds_read_b64_tr_b16 a[64:65], v60 offset:0
  ds_read_b64_tr_b16 a[66:67], v60 offset:1024
  ds_read_b64_tr_b16 a[68:69], v60 offset:4096
  ds_read_b64_tr_b16 a[70:71], v60 offset:5120
  s_waitcnt lgkmcnt(0)
  s_waitcnt vmcnt(12)
  s_barrier
  s_lshl_b32 s57, s34, 16
  s_add_u32 s57, s57, s58
  s_add_u32 s57, s57, 4194304
  s_lshl_b32 s61, s34, 11
  s_add_u32 m0, s61, 81920
  s_nop 0
  buffer_load_dwordx4 v61, s[16:19], s57 offen nt lds
  s_lshl_b32 s57, s34, 16
  s_add_u32 s57, s57, s58
  s_add_u32 s57, s57, 4227072
  s_lshl_b32 s61, s34, 11
  s_add_u32 m0, s61, 82944
  s_nop 0
  buffer_load_dwordx4 v61, s[16:19], s57 offen nt lds
  ds_read_b64_tr_b16 a[72:73], v60 offset:8192
  ds_read_b64_tr_b16 a[74:75], v60 offset:9216
  ds_read_b64_tr_b16 a[76:77], v60 offset:12288
  ds_read_b64_tr_b16 a[78:79], v60 offset:13312
  s_waitcnt lgkmcnt(0)
  s_waitcnt vmcnt(12)
  s_barrier
  s_lshl_b32 s57, s34, 16
  s_add_u32 s57, s57, s58
  s_add_u32 s57, s57, 4456448
  s_lshl_b32 s61, s34, 11
  s_add_u32 m0, s61, 90112
  s_nop 0
  buffer_load_dwordx4 v61, s[16:19], s57 offen nt lds
  s_lshl_b32 s57, s34, 16
  s_add_u32 s57, s57, s58
  s_add_u32 s57, s57, 4489216
  s_lshl_b32 s61, s34, 11
  s_add_u32 m0, s61, 91136
  s_nop 0
  buffer_load_dwordx4 v61, s[16:19], s57 offen nt lds
  ds_read_b64_tr_b16 a[80:81], v60 offset:16384
  ds_read_b64_tr_b16 a[82:83], v60 offset:17408
  ds_read_b64_tr_b16 a[84:85], v60 offset:20480
  ds_read_b64_tr_b16 a[86:87], v60 offset:21504
  s_waitcnt lgkmcnt(0)
  s_waitcnt vmcnt(12)
  s_barrier
  s_lshl_b32 s57, s34, 16
  s_add_u32 s57, s57, s58
  s_add_u32 s57, s57, 4718592
  s_lshl_b32 s61, s34, 11
  s_add_u32 m0, s61, 98304
  s_nop 0
  buffer_load_dwordx4 v61, s[16:19], s57 offen nt lds
  s_lshl_b32 s57, s34, 16
  s_add_u32 s57, s57, s58
  s_add_u32 s57, s57, 4751360
  s_lshl_b32 s61, s34, 11
  s_add_u32 m0, s61, 99328
  s_nop 0
  buffer_load_dwordx4 v61, s[16:19], s57 offen nt lds
  ds_read_b64_tr_b16 a[88:89], v60 offset:24576
  ds_read_b64_tr_b16 a[90:91], v60 offset:25600
  ds_read_b64_tr_b16 a[92:93], v60 offset:28672
  ds_read_b64_tr_b16 a[94:95], v60 offset:29696
  s_waitcnt lgkmcnt(0)
  s_waitcnt vmcnt(12)
  s_barrier
  s_lshl_b32 s57, s34, 16
  s_add_u32 s57, s57, s58
  s_add_u32 s57, s57, 4980736
  s_lshl_b32 s61, s34, 11
  s_add_u32 m0, s61, 106496
  s_nop 0
  buffer_load_dwordx4 v61, s[16:19], s57 offen nt lds
  s_lshl_b32 s57, s34, 16
  s_add_u32 s57, s57, s58
  s_add_u32 s57, s57, 5013504
  s_lshl_b32 s61, s34, 11
  s_add_u32 m0, s61, 107520
  s_nop 0
  buffer_load_dwordx4 v61, s[16:19], s57 offen nt lds
  ds_read_b64_tr_b16 a[96:97], v60 offset:32768
  ds_read_b64_tr_b16 a[98:99], v60 offset:33792
  ds_read_b64_tr_b16 a[100:101], v60 offset:36864
  ds_read_b64_tr_b16 a[102:103], v60 offset:37888
  s_waitcnt lgkmcnt(0)
  s_waitcnt vmcnt(12)
  s_barrier
  ds_read_b64_tr_b16 a[104:105], v60 offset:40960
  ds_read_b64_tr_b16 a[106:107], v60 offset:41984
  ds_read_b64_tr_b16 a[108:109], v60 offset:45056
  ds_read_b64_tr_b16 a[110:111], v60 offset:46080
  s_waitcnt lgkmcnt(0)
  s_waitcnt vmcnt(10)
  s_barrier
  ds_read_b64_tr_b16 a[112:113], v60 offset:49152
  ds_read_b64_tr_b16 a[114:115], v60 offset:50176
  ds_read_b64_tr_b16 a[116:117], v60 offset:53248
  ds_read_b64_tr_b16 a[118:119], v60 offset:54272
  s_waitcnt lgkmcnt(0)
  s_waitcnt vmcnt(8)
  s_barrier
  ds_read_b64_tr_b16 a[120:121], v60 offset:57344
  ds_read_b64_tr_b16 a[122:123], v60 offset:58368
  ds_read_b64_tr_b16 a[124:125], v60 offset:61440
  ds_read_b64_tr_b16 a[126:127], v60 offset:62464
  s_waitcnt lgkmcnt(0)
  s_waitcnt vmcnt(6)
  s_barrier
  ds_read_b64_tr_b16 a[128:129], v60 offset:0
  ds_read_b64_tr_b16 a[130:131], v60 offset:1024
  ds_read_b64_tr_b16 a[132:133], v60 offset:4096
  ds_read_b64_tr_b16 a[134:135], v60 offset:5120
  s_waitcnt lgkmcnt(0)
  s_waitcnt vmcnt(4)
  s_barrier
  ds_read_b64_tr_b16 a[136:137], v60 offset:8192
  ds_read_b64_tr_b16 a[138:139], v60 offset:9216
  ds_read_b64_tr_b16 a[140:141], v60 offset:12288
  ds_read_b64_tr_b16 a[142:143], v60 offset:13312
  s_waitcnt lgkmcnt(0)
  s_waitcnt vmcnt(2)
  s_barrier
  ds_read_b64_tr_b16 a[144:145], v60 offset:16384
  ds_read_b64_tr_b16 a[146:147], v60 offset:17408
  ds_read_b64_tr_b16 a[148:149], v60 offset:20480
  ds_read_b64_tr_b16 a[150:151], v60 offset:21504
  s_waitcnt lgkmcnt(0)
  s_waitcnt vmcnt(0)
  s_barrier
  ds_read_b64_tr_b16 a[152:153], v60 offset:24576
  ds_read_b64_tr_b16 a[154:155], v60 offset:25600
  ds_read_b64_tr_b16 a[156:157], v60 offset:28672
  ds_read_b64_tr_b16 a[158:159], v60 offset:29696
  s_waitcnt lgkmcnt(0)
  s_barrier
  v_and_b32 v20, 63, v0
  v_lshlrev_b32 v0, 4, v20
  v_and_b32 v21, 31, v20
  v_lshrrev_b32 v22, 5, v20
  v_and_b32 v23, 15, v21
  v_xor_b32 v23, v23, v22
  v_lshlrev_b32 v23, 4, v23
  v_mul_u32_u24 v24, 1280, v21
  v_add_u32 v1, v24, v23
  v_xor_b32 v2, 32, v1
  v_xor_b32 v3, 64, v1
  v_xor_b32 v4, 96, v1
  v_xor_b32 v5, 128, v1
  v_xor_b32 v6, 160, v1
  v_xor_b32 v7, 192, v1
  v_xor_b32 v8, 224, v1
  s_lshl_b32 s57, s34, 3
  v_add_u32 v21, 0, v20
  v_mul_u32_u24 v22, 52429, v21
  v_lshrrev_b32 v22, 22, v22
  v_mul_u32_u24 v23, 80, v22
  v_sub_u32 v23, v21, v23
  v_add_u32 v22, s57, v22
  v_and_b32 v24, 15, v22
  v_and_b32 v25, 15, v23
  v_xor_b32 v24, v24, v25
  v_and_b32 v25, 0x70, v23
  v_add_u32 v24, v24, v25
  v_lshlrev_b32 v24, 4, v24
  v_mul_u32_u24 v25, 1280, v22
  v_add_u32 v9, v24, v25
  v_add_u32 v21, 64, v20
  v_mul_u32_u24 v22, 52429, v21
  v_lshrrev_b32 v22, 22, v22
  v_mul_u32_u24 v23, 80, v22
  v_sub_u32 v23, v21, v23
  v_add_u32 v22, s57, v22
  v_and_b32 v24, 15, v22
  v_and_b32 v25, 15, v23
  v_xor_b32 v24, v24, v25
  v_and_b32 v25, 0x70, v23
  v_add_u32 v24, v24, v25
  v_lshlrev_b32 v24, 4, v24
  v_mul_u32_u24 v25, 1280, v22
  v_add_u32 v10, v24, v25
  v_add_u32 v21, 128, v20
  v_mul_u32_u24 v22, 52429, v21
  v_lshrrev_b32 v22, 22, v22
  v_mul_u32_u24 v23, 80, v22
  v_sub_u32 v23, v21, v23
  v_add_u32 v22, s57, v22
  v_and_b32 v24, 15, v22
  v_and_b32 v25, 15, v23
  v_xor_b32 v24, v24, v25
  v_and_b32 v25, 0x70, v23
  v_add_u32 v24, v24, v25
  v_lshlrev_b32 v24, 4, v24
  v_mul_u32_u24 v25, 1280, v22
  v_add_u32 v11, v24, v25
  v_add_u32 v21, 192, v20
  v_mul_u32_u24 v22, 52429, v21
  v_lshrrev_b32 v22, 22, v22
  v_mul_u32_u24 v23, 80, v22
  v_sub_u32 v23, v21, v23
  v_add_u32 v22, s57, v22
  v_and_b32 v24, 15, v22
  v_and_b32 v25, 15, v23
  v_xor_b32 v24, v24, v25
  v_and_b32 v25, 0x70, v23
  v_add_u32 v24, v24, v25
  v_lshlrev_b32 v24, 4, v24
  v_mul_u32_u24 v25, 1280, v22
  v_add_u32 v12, v24, v25
  v_add_u32 v21, 256, v20
  v_mul_u32_u24 v22, 52429, v21
  v_lshrrev_b32 v22, 22, v22
  v_mul_u32_u24 v23, 80, v22
  v_sub_u32 v23, v21, v23
  v_add_u32 v22, s57, v22
  v_and_b32 v24, 15, v22
  v_and_b32 v25, 15, v23
  v_xor_b32 v24, v24, v25
  v_and_b32 v25, 0x70, v23
  v_add_u32 v24, v24, v25
  v_lshlrev_b32 v24, 4, v24
  v_mul_u32_u24 v25, 1280, v22
  v_add_u32 v13, v24, v25
  v_add_u32 v21, 320, v20
  v_mul_u32_u24 v22, 52429, v21
  v_lshrrev_b32 v22, 22, v22
  v_mul_u32_u24 v23, 80, v22
  v_sub_u32 v23, v21, v23
  v_add_u32 v22, s57, v22
  v_and_b32 v24, 15, v22
  v_and_b32 v25, 15, v23
  v_xor_b32 v24, v24, v25
  v_and_b32 v25, 0x70, v23
  v_add_u32 v24, v24, v25
  v_lshlrev_b32 v24, 4, v24
  v_mul_u32_u24 v25, 1280, v22
  v_add_u32 v14, v24, v25
  v_add_u32 v21, 384, v20
  v_mul_u32_u24 v22, 52429, v21
  v_lshrrev_b32 v22, 22, v22
  v_mul_u32_u24 v23, 80, v22
  v_sub_u32 v23, v21, v23
  v_add_u32 v22, s57, v22
  v_and_b32 v24, 15, v22
  v_and_b32 v25, 15, v23
  v_xor_b32 v24, v24, v25
  v_and_b32 v25, 0x70, v23
  v_add_u32 v24, v24, v25
  v_lshlrev_b32 v24, 4, v24
  v_mul_u32_u24 v25, 1280, v22
  v_add_u32 v15, v24, v25
  v_add_u32 v21, 448, v20
  v_mul_u32_u24 v22, 52429, v21
  v_lshrrev_b32 v22, 22, v22
  v_mul_u32_u24 v23, 80, v22
  v_sub_u32 v23, v21, v23
  v_add_u32 v22, s57, v22
  v_and_b32 v24, 15, v22
  v_and_b32 v25, 15, v23
  v_xor_b32 v24, v24, v25
  v_and_b32 v25, 0x70, v23
  v_add_u32 v24, v24, v25
  v_lshlrev_b32 v24, 4, v24
  v_mul_u32_u24 v25, 1280, v22
  v_add_u32 v16, v24, v25
  v_add_u32 v21, 512, v20
  v_mul_u32_u24 v22, 52429, v21
  v_lshrrev_b32 v22, 22, v22
  v_mul_u32_u24 v23, 80, v22
  v_sub_u32 v23, v21, v23
  v_add_u32 v22, s57, v22
  v_and_b32 v24, 15, v22
  v_and_b32 v25, 15, v23
  v_xor_b32 v24, v24, v25
  v_and_b32 v25, 0x70, v23
  v_add_u32 v24, v24, v25
  v_lshlrev_b32 v24, 4, v24
  v_mul_u32_u24 v25, 1280, v22
  v_add_u32 v17, v24, v25
  v_add_u32 v21, 576, v20
  v_mul_u32_u24 v22, 52429, v21
  v_lshrrev_b32 v22, 22, v22
  v_mul_u32_u24 v23, 80, v22
  v_sub_u32 v23, v21, v23
  v_add_u32 v22, s57, v22
  v_and_b32 v24, 15, v22
  v_and_b32 v25, 15, v23
  v_xor_b32 v24, v24, v25
  v_and_b32 v25, 0x70, v23
  v_add_u32 v24, v24, v25
  v_lshlrev_b32 v24, 4, v24
  v_mul_u32_u24 v25, 1280, v22
  v_add_u32 v18, v24, v25
  v_lshrrev_b32 v21, 4, v0
  v_and_b32 v22, 31, v21
  v_lshrrev_b32 v23, 5, v21
  v_lshrrev_b32 v24, 4, v22
  v_and_b32 v25, 15, v22
  v_lshlrev_b32 v24, 12, v24
  v_lshl_add_u32 v24, v25, 4, v24
  v_lshl_add_u32 v24, v23, 8, v24
  s_lshl_b32 s57, s34, 10
  v_add_u32 v19, s57, v24
  v_and_b32 v24, 1, v22
  v_lshrrev_b32 v25, 1, v22
  v_lshlrev_b32 v24, 10, v24
  v_lshl_add_u32 v24, v25, 4, v24
  v_lshl_add_u32 v24, v23, 8, v24
  s_lshl_b32 s57, s34, 11
  v_add_u32 v20, s57, v24
  s_lshl_b32 s57, s32, 11
  s_add_u32 s57, s57, s33
  s_lshl_b32 s57, s57, 13
  s_add_u32 s38, s57, 33554432
  s_add_u32 s39, s57, 67108864
  s_mov_b32 s37, 0
  s_mov_b32 s40, 0
  s_mov_b32 s41, 40960
  s_mov_b32 s35, 0
  s_mul_i32 s61, s34, 10240
  s_add_u32 m0, s61, s40
  s_nop 0
  s_nop 0
  buffer_load_dwordx4 v9, s[24:27], s37 offen lds
  s_add_u32 m0, m0, 1024
  s_nop 0
  buffer_load_dwordx4 v10, s[24:27], s37 offen lds
  s_add_u32 m0, m0, 1024
  s_nop 0
  buffer_load_dwordx4 v11, s[24:27], s37 offen lds
  s_add_u32 m0, m0, 1024
  s_nop 0
  buffer_load_dwordx4 v12, s[24:27], s37 offen lds
  s_add_u32 m0, m0, 1024
  s_nop 0
  buffer_load_dwordx4 v13, s[24:27], s37 offen lds
  s_add_u32 m0, m0, 1024
  s_nop 0
  buffer_load_dwordx4 v14, s[24:27], s37 offen lds
  s_add_u32 m0, m0, 1024
  s_nop 0
  buffer_load_dwordx4 v15, s[24:27], s37 offen lds
  s_add_u32 m0, m0, 1024
  s_nop 0
  buffer_load_dwordx4 v16, s[24:27], s37 offen lds
  s_add_u32 m0, m0, 1024
  s_nop 0
  buffer_load_dwordx4 v17, s[24:27], s37 offen lds
  s_add_u32 m0, m0, 1024
  s_nop 0
  buffer_load_dwordx4 v18, s[24:27], s37 offen lds
  s_mov_b32 s42, 0x40000000
  s_mov_b32 s43, 0x40000000
Lg1_seg:
  s_cmp_lt_u32 s35, 4
  s_cbranch_scc1 Lg1_strict
  s_waitcnt vmcnt(5)
  s_sub_u32 s59, s35, 2
  s_branch Lg1_go
Lg1_strict:
  s_waitcnt vmcnt(0)
  s_max_u32 s59, s35, 1
  s_sub_u32 s59, s59, 1
Lg1_go:
  s_barrier
  s_add_u32 s37, s37, 40960
  s_mul_i32 s61, s34, 10240
  s_add_u32 s62, s61, s41
  v_mov_b32 v22, 0
  s_cmp_eq_u32 s34, 0
  s_cselect_b32 s63, s36, 0x40000000
  s_cmp_eq_u32 s40, 0
  s_cbranch_scc0 Lg1_odd
  ds_read_b128 v[24:27], v1 offset:0
  ds_read_b128 v[28:31], v2 offset:0
  s_waitcnt lgkmcnt(1)
  v_mfma_f32_32x32x16_bf16 v[64:79], v[96:99], v[24:27], 0
  ds_read_b128 v[32:35], v3 offset:0
  s_add_u32 m0, s62, 0
  v_mfma_f32_32x32x16_bf16 v[80:95], v[24:27], a[0:3], 0
  buffer_load_dwordx4 v9, s[24:27], s37 offen lds
  s_waitcnt lgkmcnt(1)
  v_mfma_f32_32x32x16_bf16 v[64:79], v[100:103], v[28:31], v[64:79]
  ds_read_b128 v[24:27], v4 offset:0
  v_mfma_f32_32x32x16_bf16 v[80:95], v[28:31], a[4:7], v[80:95]
  s_waitcnt lgkmcnt(1)
  v_mfma_f32_32x32x16_bf16 v[64:79], v[104:107], v[32:35], v[64:79]
  ds_read_b128 v[28:31], v5 offset:0
  s_add_u32 m0, s62, 1024
  v_mfma_f32_32x32x16_bf16 v[80:95], v[32:35], a[8:11], v[80:95]
  buffer_load_dwordx4 v10, s[24:27], s37 offen lds
  s_waitcnt lgkmcnt(1)
  v_mfma_f32_32x32x16_bf16 v[64:79], v[108:111], v[24:27], v[64:79]
  ds_read_b128 v[32:35], v6 offset:0
  v_mfma_f32_32x32x16_bf16 v[80:95], v[24:27], a[12:15], v[80:95]
  s_waitcnt lgkmcnt(1)
  v_mfma_f32_32x32x16_bf16 v[64:79], v[112:115], v[28:31], v[64:79]
  ds_read_b128 v[24:27], v7 offset:0
  s_add_u32 m0, s62, 2048
  v_mfma_f32_32x32x16_bf16 v[80:95], v[28:31], a[16:19], v[80:95]
  buffer_load_dwordx4 v11, s[24:27], s37 offen lds
  s_waitcnt lgkmcnt(1)
  v_mfma_f32_32x32x16_bf16 v[64:79], v[116:119], v[32:35], v[64:79]
  ds_read_b128 v[28:31], v8 offset:0
  v_mfma_f32_32x32x16_bf16 v[80:95], v[32:35], a[20:23], v[80:95]
  s_waitcnt lgkmcnt(1)
  v_mfma_f32_32x32x16_bf16 v[64:79], v[120:123], v[24:27], v[64:79]
  ds_read_b128 v[32:35], v1 offset:256
  s_add_u32 m0, s62, 3072
  v_mfma_f32_32x32x16_bf16 v[80:95], v[24:27], a[24:27], v[80:95]
  buffer_load_dwordx4 v12, s[24:27], s37 offen lds
  s_waitcnt lgkmcnt(1)
  v_mfma_f32_32x32x16_bf16 v[64:79], v[124:127], v[28:31], v[64:79]
  ds_read_b128 v[24:27], v2 offset:256
  v_mfma_f32_32x32x16_bf16 v[80:95], v[28:31], a[28:31], v[80:95]
  s_waitcnt lgkmcnt(1)
  v_mfma_f32_32x32x16_bf16 v[64:79], v[128:131], v[32:35], v[64:79]
  ds_read_b128 v[28:31], v3 offset:256
  s_add_u32 m0, s62, 4096
  v_mfma_f32_32x32x16_bf16 v[80:95], v[32:35], a[32:35], v[80:95]
  buffer_load_dwordx4 v13, s[24:27], s37 offen lds
  s_waitcnt lgkmcnt(1)
  v_mfma_f32_32x32x16_bf16 v[64:79], v[132:135], v[24:27], v[64:79]
  ds_read_b128 v[32:35], v4 offset:256
  v_mfma_f32_32x32x16_bf16 v[80:95], v[24:27], a[36:39], v[80:95]
  s_waitcnt lgkmcnt(1)
  v_mfma_f32_32x32x16_bf16 v[64:79], v[136:139], v[28:31], v[64:79]
  ds_read_b128 v[24:27], v5 offset:256
  s_add_u32 m0, s62, 5120
  v_mfma_f32_32x32x16_bf16 v[80:95], v[28:31], a[40:43], v[80:95]
  buffer_load_dwordx4 v14, s[24:27], s37 offen lds
  s_waitcnt lgkmcnt(1)
  v_mfma_f32_32x32x16_bf16 v[64:79], v[140:143], v[32:35], v[64:79]
  ds_read_b128 v[28:31], v6 offset:256
  v_mfma_f32_32x32x16_bf16 v[80:95], v[32:35], a[44:47], v[80:95]
  s_waitcnt lgkmcnt(1)
  v_mfma_f32_32x32x16_bf16 v[64:79], v[144:147], v[24:27], v[64:79]
  ds_read_b128 v[32:35], v7 offset:256
  s_add_u32 m0, s62, 6144
  v_mfma_f32_32x32x16_bf16 v[80:95], v[24:27], a[48:51], v[80:95]
  buffer_load_dwordx4 v15, s[24:27], s37 offen lds
  s_waitcnt lgkmcnt(1)
  v_mfma_f32_32x32x16_bf16 v[64:79], v[148:151], v[28:31], v[64:79]
  ds_read_b128 v[24:27], v8 offset:256
  v_mfma_f32_32x32x16_bf16 v[80:95], v[28:31], a[52:55], v[80:95]
  s_waitcnt lgkmcnt(1)
  v_mfma_f32_32x32x16_bf16 v[64:79], v[152:155], v[32:35], v[64:79]
  ds_read_b128 v[28:31], v1 offset:512
  s_add_u32 m0, s62, 7168
  v_mfma_f32_32x32x16_bf16 v[80:95], v[32:35], a[56:59], v[80:95]
  buffer_load_dwordx4 v16, s[24:27], s37 offen lds
  s_waitcnt lgkmcnt(1)
  v_mfma_f32_32x32x16_bf16 v[64:79], v[156:159], v[24:27], v[64:79]
  ds_read_b128 v[32:35], v2 offset:512
  v_mfma_f32_32x32x16_bf16 v[80:95], v[24:27], a[60:63], v[80:95]
  s_waitcnt lgkmcnt(1)
  v_mfma_f32_32x32x16_bf16 v[64:79], v[160:163], v[28:31], v[64:79]
  ds_read_b128 v[24:27], v3 offset:512
  s_add_u32 m0, s62, 8192
  v_mfma_f32_32x32x16_bf16 v[80:95], v[28:31], a[64:67], v[80:95]
  buffer_load_dwordx4 v17, s[24:27], s37 offen lds
  s_waitcnt lgkmcnt(1)
  v_mfma_f32_32x32x16_bf16 v[64:79], v[164:167], v[32:35], v[64:79]
  ds_read_b128 v[28:31], v4 offset:512
  v_mfma_f32_32x32x16_bf16 v[80:95], v[32:35], a[68:71], v[80:95]
  s_waitcnt lgkmcnt(1)
  v_mfma_f32_32x32x16_bf16 v[64:79], v[168:171], v[24:27], v[64:79]
  ds_read_b128 v[32:35], v5 offset:512
  s_add_u32 m0, s62, 9216
  v_mfma_f32_32x32x16_bf16 v[80:95], v[24:27], a[72:75], v[80:95]
  buffer_load_dwordx4 v18, s[24:27], s37 offen lds
  s_waitcnt lgkmcnt(1)
  v_mfma_f32_32x32x16_bf16 v[64:79], v[172:175], v[28:31], v[64:79]
  ds_read_b128 v[24:27], v6 offset:512
  v_mfma_f32_32x32x16_bf16 v[80:95], v[28:31], a[76:79], v[80:95]
  s_waitcnt lgkmcnt(1)
  v_mfma_f32_32x32x16_bf16 v[64:79], v[176:179], v[32:35], v[64:79]
  ds_read_b128 v[28:31], v7 offset:512
  v_mfma_f32_32x32x16_bf16 v[80:95], v[32:35], a[80:83], v[80:95]
  s_waitcnt lgkmcnt(1)
  v_mfma_f32_32x32x16_bf16 v[64:79], v[180:183], v[24:27], v[64:79]
  ds_read_b128 v[32:35], v8 offset:512
  v_mfma_f32_32x32x16_bf16 v[80:95], v[24:27], a[84:87], v[80:95]
  s_waitcnt lgkmcnt(1)
  v_mfma_f32_32x32x16_bf16 v[64:79], v[184:187], v[28:31], v[64:79]
  ds_read_b128 v[24:27], v1 offset:768
  buffer_store_dwordx4 v[44:47], v20, s[4:7], s43 offen sc1
  v_mfma_f32_32x32x16_bf16 v[80:95], v[28:31], a[88:91], v[80:95]
  s_waitcnt lgkmcnt(1)
  v_mfma_f32_32x32x16_bf16 v[64:79], v[188:191], v[32:35], v[64:79]
  ds_read_b128 v[28:31], v2 offset:768
  v_mfma_f32_32x32x16_bf16 v[80:95], v[32:35], a[92:95], v[80:95]
  s_waitcnt lgkmcnt(1)
  v_mfma_f32_32x32x16_bf16 v[64:79], v[192:195], v[24:27], v[64:79]
  ds_read_b128 v[32:35], v3 offset:768
  v_mfma_f32_32x32x16_bf16 v[80:95], v[24:27], a[96:99], v[80:95]
  s_waitcnt lgkmcnt(1)
  v_mfma_f32_32x32x16_bf16 v[64:79], v[196:199], v[28:31], v[64:79]
  ds_read_b128 v[24:27], v4 offset:768
  v_mfma_f32_32x32x16_bf16 v[80:95], v[28:31], a[100:103], v[80:95]
  s_waitcnt lgkmcnt(1)
  v_mfma_f32_32x32x16_bf16 v[64:79], v[200:203], v[32:35], v[64:79]
  ds_read_b128 v[28:31], v5 offset:768
  buffer_store_dwordx4 v[48:51], v20, s[4:7], s43 offen offset:512 sc1
  v_mfma_f32_32x32x16_bf16 v[80:95], v[32:35], a[104:107], v[80:95]
  s_waitcnt lgkmcnt(1)
  v_mfma_f32_32x32x16_bf16 v[64:79], v[204:207], v[24:27], v[64:79]
  ds_read_b128 v[32:35], v6 offset:768
  v_mfma_f32_32x32x16_bf16 v[80:95], v[24:27], a[108:111], v[80:95]
  s_waitcnt lgkmcnt(1)
  v_mfma_f32_32x32x16_bf16 v[64:79], v[208:211], v[28:31], v[64:79]
  ds_read_b128 v[24:27], v7 offset:768
  v_mfma_f32_32x32x16_bf16 v[80:95], v[28:31], a[112:115], v[80:95]
  s_waitcnt lgkmcnt(1)
  v_mfma_f32_32x32x16_bf16 v[64:79], v[212:215], v[32:35], v[64:79]
  ds_read_b128 v[28:31], v8 offset:768
  v_mfma_f32_32x32x16_bf16 v[80:95], v[32:35], a[116:119], v[80:95]
  s_waitcnt lgkmcnt(1)
  v_mfma_f32_32x32x16_bf16 v[64:79], v[216:219], v[24:27], v[64:79]
  ds_read_b128 v[32:35], v1 offset:1024
  buffer_store_dwordx4 v[36:39], v19, s[4:7], s42 offen sc1
  v_mfma_f32_32x32x16_bf16 v[80:95], v[24:27], a[120:123], v[80:95]
  s_waitcnt lgkmcnt(1)
  v_mfma_f32_32x32x16_bf16 v[64:79], v[220:223], v[28:31], v[64:79]
  ds_read_b128 v[24:27], v2 offset:1024
  v_mfma_f32_32x32x16_bf16 v[80:95], v[28:31], a[124:127], v[80:95]
  s_waitcnt lgkmcnt(1)
  v_mfma_f32_32x32x16_bf16 v[64:79], v[224:227], v[32:35], v[64:79]
  ds_read_b128 v[28:31], v3 offset:1024
  v_mfma_f32_32x32x16_bf16 v[80:95], v[32:35], a[128:131], v[80:95]
  s_waitcnt lgkmcnt(1)
  v_mfma_f32_32x32x16_bf16 v[64:79], v[228:231], v[24:27], v[64:79]
  ds_read_b128 v[32:35], v4 offset:1024
  v_mfma_f32_32x32x16_bf16 v[80:95], v[24:27], a[132:135], v[80:95]
  s_waitcnt lgkmcnt(1)
  v_mfma_f32_32x32x16_bf16 v[64:79], v[232:235], v[28:31], v[64:79]
  ds_read_b128 v[24:27], v5 offset:1024
  buffer_store_dwordx4 v[40:43], v19, s[4:7], s42 offen offset:512 sc1
  v_mfma_f32_32x32x16_bf16 v[80:95], v[28:31], a[136:139], v[80:95]
  s_waitcnt lgkmcnt(1)
  v_mfma_f32_32x32x16_bf16 v[64:79], v[236:239], v[32:35], v[64:79]
  ds_read_b128 v[28:31], v6 offset:1024
  v_mfma_f32_32x32x16_bf16 v[80:95], v[32:35], a[140:143], v[80:95]
  s_waitcnt lgkmcnt(1)
  v_mfma_f32_32x32x16_bf16 v[64:79], v[240:243], v[24:27], v[64:79]
  ds_read_b128 v[32:35], v7 offset:1024
  v_mfma_f32_32x32x16_bf16 v[80:95], v[24:27], a[144:147], v[80:95]
  s_waitcnt lgkmcnt(1)
  v_mfma_f32_32x32x16_bf16 v[64:79], v[244:247], v[28:31], v[64:79]
  ds_read_b128 v[24:27], v8 offset:1024
  v_mfma_f32_32x32x16_bf16 v[80:95], v[28:31], a[148:151], v[80:95]
  s_waitcnt lgkmcnt(1)
  v_mfma_f32_32x32x16_bf16 v[64:79], v[248:251], v[32:35], v[64:79]
  v_mov_b32 v21, s59
  s_mov_b64 exec, 1
  buffer_store_dword v21, v22, s[4:7], s63 offen sc1
  s_mov_b64 exec, -1
  v_mfma_f32_32x32x16_bf16 v[80:95], v[32:35], a[152:155], v[80:95]
  s_waitcnt lgkmcnt(0)
  v_mfma_f32_32x32x16_bf16 v[64:79], v[252:255], v[24:27], v[64:79]
  v_mfma_f32_32x32x16_bf16 v[80:95], v[24:27], a[156:159], v[80:95]
  s_branch Lg1_epi
Lg1_odd:
  ds_read_b128 v[24:27], v1 offset:40960
  ds_read_b128 v[28:31], v2 offset:40960
  s_waitcnt lgkmcnt(1)
  v_mfma_f32_32x32x16_bf16 v[64:79], v[96:99], v[24:27], 0
  ds_read_b128 v[32:35], v3 offset:40960
  s_add_u32 m0, s62, 0
  v_mfma_f32_32x32x16_bf16 v[80:95], v[24:27], a[0:3], 0
  buffer_load_dwordx4 v9, s[24:27], s37 offen lds
  s_waitcnt lgkmcnt(1)
  v_mfma_f32_32x32x16_bf16 v[64:79], v[100:103], v[28:31], v[64:79]
  ds_read_b128 v[24:27], v4 offset:40960
  v_mfma_f32_32x32x16_bf16 v[80:95], v[28:31], a[4:7], v[80:95]
  s_waitcnt lgkmcnt(1)
  v_mfma_f32_32x32x16_bf16 v[64:79], v[104:107], v[32:35], v[64:79]
  ds_read_b128 v[28:31], v5 offset:40960
  s_add_u32 m0, s62, 1024
  v_mfma_f32_32x32x16_bf16 v[80:95], v[32:35], a[8:11], v[80:95]
  buffer_load_dwordx4 v10, s[24:27], s37 offen lds
  s_waitcnt lgkmcnt(1)
  v_mfma_f32_32x32x16_bf16 v[64:79], v[108:111], v[24:27], v[64:79]
  ds_read_b128 v[32:35], v6 offset:40960
  v_mfma_f32_32x32x16_bf16 v[80:95], v[24:27], a[12:15], v[80:95]
  s_waitcnt lgkmcnt(1)
  v_mfma_f32_32x32x16_bf16 v[64:79], v[112:115], v[28:31], v[64:79]
  ds_read_b128 v[24:27], v7 offset:40960
  s_add_u32 m0, s62, 2048
  v_mfma_f32_32x32x16_bf16 v[80:95], v[28:31], a[16:19], v[80:95]
  buffer_load_dwordx4 v11, s[24:27], s37 offen lds
  s_waitcnt lgkmcnt(1)
  v_mfma_f32_32x32x16_bf16 v[64:79], v[116:119], v[32:35], v[64:79]
  ds_read_b128 v[28:31], v8 offset:40960
  v_mfma_f32_32x32x16_bf16 v[80:95], v[32:35], a[20:23], v[80:95]
  s_waitcnt lgkmcnt(1)
  v_mfma_f32_32x32x16_bf16 v[64:79], v[120:123], v[24:27], v[64:79]
  ds_read_b128 v[32:35], v1 offset:41216
  s_add_u32 m0, s62, 3072
  v_mfma_f32_32x32x16_bf16 v[80:95], v[24:27], a[24:27], v[80:95]
  buffer_load_dwordx4 v12, s[24:27], s37 offen lds
  s_waitcnt lgkmcnt(1)
  v_mfma_f32_32x32x16_bf16 v[64:79], v[124:127], v[28:31], v[64:79]
  ds_read_b128 v[24:27], v2 offset:41216
  v_mfma_f32_32x32x16_bf16 v[80:95], v[28:31], a[28:31], v[80:95]
  s_waitcnt lgkmcnt(1)
  v_mfma_f32_32x32x16_bf16 v[64:79], v[128:131], v[32:35], v[64:79]
  ds_read_b128 v[28:31], v3 offset:41216
  s_add_u32 m0, s62, 4096
  v_mfma_f32_32x32x16_bf16 v[80:95], v[32:35], a[32:35], v[80:95]
  buffer_load_dwordx4 v13, s[24:27], s37 offen lds
  s_waitcnt lgkmcnt(1)
  v_mfma_f32_32x32x16_bf16 v[64:79], v[132:135], v[24:27], v[64:79]
  ds_read_b128 v[32:35], v4 offset:41216
  v_mfma_f32_32x32x16_bf16 v[80:95], v[24:27], a[36:39], v[80:95]
  s_waitcnt lgkmcnt(1)
  v_mfma_f32_32x32x16_bf16 v[64:79], v[136:139], v[28:31], v[64:79]
  ds_read_b128 v[24:27], v5 offset:41216
  s_add_u32 m0, s62, 5120
  v_mfma_f32_32x32x16_bf16 v[80:95], v[28:31], a[40:43], v[80:95]
  buffer_load_dwordx4 v14, s[24:27], s37 offen lds
  s_waitcnt lgkmcnt(1)
  v_mfma_f32_32x32x16_bf16 v[64:79], v[140:143], v[32:35], v[64:79]
  ds_read_b128 v[28:31], v6 offset:41216
  v_mfma_f32_32x32x16_bf16 v[80:95], v[32:35], a[44:47], v[80:95]
  s_waitcnt lgkmcnt(1)
  v_mfma_f32_32x32x16_bf16 v[64:79], v[144:147], v[24:27], v[64:79]
  ds_read_b128 v[32:35], v7 offset:41216
  s_add_u32 m0, s62, 6144
  v_mfma_f32_32x32x16_bf16 v[80:95], v[24:27], a[48:51], v[80:95]
  buffer_load_dwordx4 v15, s[24:27], s37 offen lds
  s_waitcnt lgkmcnt(1)
  v_mfma_f32_32x32x16_bf16 v[64:79], v[148:151], v[28:31], v[64:79]
  ds_read_b128 v[24:27], v8 offset:41216
  v_mfma_f32_32x32x16_bf16 v[80:95], v[28:31], a[52:55], v[80:95]
  s_waitcnt lgkmcnt(1)
  v_mfma_f32_32x32x16_bf16 v[64:79], v[152:155], v[32:35], v[64:79]
  ds_read_b128 v[28:31], v1 offset:41472
  s_add_u32 m0, s62, 7168
  v_mfma_f32_32x32x16_bf16 v[80:95], v[32:35], a[56:59], v[80:95]
  buffer_load_dwordx4 v16, s[24:27], s37 offen lds
  s_waitcnt lgkmcnt(1)
  v_mfma_f32_32x32x16_bf16 v[64:79], v[156:159], v[24:27], v[64:79]
  ds_read_b128 v[32:35], v2 offset:41472
  v_mfma_f32_32x32x16_bf16 v[80:95], v[24:27], a[60:63], v[80:95]
  s_waitcnt lgkmcnt(1)
  v_mfma_f32_32x32x16_bf16 v[64:79], v[160:163], v[28:31], v[64:79]
  ds_read_b128 v[24:27], v3 offset:41472
  s_add_u32 m0, s62, 8192
  v_mfma_f32_32x32x16_bf16 v[80:95], v[28:31], a[64:67], v[80:95]
  buffer_load_dwordx4 v17, s[24:27], s37 offen lds
  s_waitcnt lgkmcnt(1)
  v_mfma_f32_32x32x16_bf16 v[64:79], v[164:167], v[32:35], v[64:79]
  ds_read_b128 v[28:31], v4 offset:41472
  v_mfma_f32_32x32x16_bf16 v[80:95], v[32:35], a[68:71], v[80:95]
  s_waitcnt lgkmcnt(1)
  v_mfma_f32_32x32x16_bf16 v[64:79], v[168:171], v[24:27], v[64:79]
  ds_read_b128 v[32:35], v5 offset:41472
  s_add_u32 m0, s62, 9216
  v_mfma_f32_32x32x16_bf16 v[80:95], v[24:27], a[72:75], v[80:95]
  buffer_load_dwordx4 v18, s[24:27], s37 offen lds
  s_waitcnt lgkmcnt(1)
  v_mfma_f32_32x32x16_bf16 v[64:79], v[172:175], v[28:31], v[64:79]
  ds_read_b128 v[24:27], v6 offset:41472
  v_mfma_f32_32x32x16_bf16 v[80:95], v[28:31], a[76:79], v[80:95]
  s_waitcnt lgkmcnt(1)
  v_mfma_f32_32x32x16_bf16 v[64:79], v[176:179], v[32:35], v[64:79]
  ds_read_b128 v[28:31], v7 offset:41472
  v_mfma_f32_32x32x16_bf16 v[80:95], v[32:35], a[80:83], v[80:95]
  s_waitcnt lgkmcnt(1)
  v_mfma_f32_32x32x16_bf16 v[64:79], v[180:183], v[24:27], v[64:79]
  ds_read_b128 v[32:35], v8 offset:41472
  v_mfma_f32_32x32x16_bf16 v[80:95], v[24:27], a[84:87], v[80:95]
  s_waitcnt lgkmcnt(1)
  v_mfma_f32_32x32x16_bf16 v[64:79], v[184:187], v[28:31], v[64:79]
  ds_read_b128 v[24:27], v1 offset:41728
  buffer_store_dwordx4 v[44:47], v20, s[4:7], s43 offen sc1
  v_mfma_f32_32x32x16_bf16 v[80:95], v[28:31], a[88:91], v[80:95]
  s_waitcnt lgkmcnt(1)
  v_mfma_f32_32x32x16_bf16 v[64:79], v[188:191], v[32:35], v[64:79]
  ds_read_b128 v[28:31], v2 offset:41728
  v_mfma_f32_32x32x16_bf16 v[80:95], v[32:35], a[92:95], v[80:95]
  s_waitcnt lgkmcnt(1)
  v_mfma_f32_32x32x16_bf16 v[64:79], v[192:195], v[24:27], v[64:79]
  ds_read_b128 v[32:35], v3 offset:41728
  v_mfma_f32_32x32x16_bf16 v[80:95], v[24:27], a[96:99], v[80:95]
  s_waitcnt lgkmcnt(1)
  v_mfma_f32_32x32x16_bf16 v[64:79], v[196:199], v[28:31], v[64:79]
  ds_read_b128 v[24:27], v4 offset:41728
  v_mfma_f32_32x32x16_bf16 v[80:95], v[28:31], a[100:103], v[80:95]
  s_waitcnt lgkmcnt(1)
  v_mfma_f32_32x32x16_bf16 v[64:79], v[200:203], v[32:35], v[64:79]
  ds_read_b128 v[28:31], v5 offset:41728
  buffer_store_dwordx4 v[48:51], v20, s[4:7], s43 offen offset:512 sc1
  v_mfma_f32_32x32x16_bf16 v[80:95], v[32:35], a[104:107], v[80:95]
  s_waitcnt lgkmcnt(1)
  v_mfma_f32_32x32x16_bf16 v[64:79], v[204:207], v[24:27], v[64:79]
  ds_read_b128 v[32:35], v6 offset:41728
  v_mfma_f32_32x32x16_bf16 v[80:95], v[24:27], a[108:111], v[80:95]
  s_waitcnt lgkmcnt(1)
  v_mfma_f32_32x32x16_bf16 v[64:79], v[208:211], v[28:31], v[64:79]
  ds_read_b128 v[24:27], v7 offset:41728
  v_mfma_f32_32x32x16_bf16 v[80:95], v[28:31], a[112:115], v[80:95]
  s_waitcnt lgkmcnt(1)
  v_mfma_f32_32x32x16_bf16 v[64:79], v[212:215], v[32:35], v[64:79]
  ds_read_b128 v[28:31], v8 offset:41728
  v_mfma_f32_32x32x16_bf16 v[80:95], v[32:35], a[116:119], v[80:95]
  s_waitcnt lgkmcnt(1)
  v_mfma_f32_32x32x16_bf16 v[64:79], v[216:219], v[24:27], v[64:79]
  ds_read_b128 v[32:35], v1 offset:41984
  buffer_store_dwordx4 v[36:39], v19, s[4:7], s42 offen sc1
  v_mfma_f32_32x32x16_bf16 v[80:95], v[24:27], a[120:123], v[80:95]
  s_waitcnt lgkmcnt(1)
  v_mfma_f32_32x32x16_bf16 v[64:79], v[220:223], v[28:31], v[64:79]
  ds_read_b128 v[24:27], v2 offset:41984
  v_mfma_f32_32x32x16_bf16 v[80:95], v[28:31], a[124:127], v[80:95]
  s_waitcnt lgkmcnt(1)
  v_mfma_f32_32x32x16_bf16 v[64:79], v[224:227], v[32:35], v[64:79]
  ds_read_b128 v[28:31], v3 offset:41984
  v_mfma_f32_32x32x16_bf16 v[80:95], v[32:35], a[128:131], v[80:95]
  s_waitcnt lgkmcnt(1)
  v_mfma_f32_32x32x16_bf16 v[64:79], v[228:231], v[24:27], v[64:79]
  ds_read_b128 v[32:35], v4 offset:41984
  v_mfma_f32_32x32x16_bf16 v[80:95], v[24:27], a[132:135], v[80:95]
  s_waitcnt lgkmcnt(1)
  v_mfma_f32_32x32x16_bf16 v[64:79], v[232:235], v[28:31], v[64:79]
  ds_read_b128 v[24:27], v5 offset:41984
  buffer_store_dwordx4 v[40:43], v19, s[4:7], s42 offen offset:512 sc1
  v_mfma_f32_32x32x16_bf16 v[80:95], v[28:31], a[136:139], v[80:95]
  s_waitcnt lgkmcnt(1)
  v_mfma_f32_32x32x16_bf16 v[64:79], v[236:239], v[32:35], v[64:79]
  ds_read_b128 v[28:31], v6 offset:41984
  v_mfma_f32_32x32x16_bf16 v[80:95], v[32:35], a[140:143], v[80:95]
  s_waitcnt lgkmcnt(1)
  v_mfma_f32_32x32x16_bf16 v[64:79], v[240:243], v[24:27], v[64:79]
  ds_read_b128 v[32:35], v7 offset:41984
  v_mfma_f32_32x32x16_bf16 v[80:95], v[24:27], a[144:147], v[80:95]
  s_waitcnt lgkmcnt(1)
  v_mfma_f32_32x32x16_bf16 v[64:79], v[244:247], v[28:31], v[64:79]
  ds_read_b128 v[24:27], v8 offset:41984
  v_mfma_f32_32x32x16_bf16 v[80:95], v[28:31], a[148:151], v[80:95]
  s_waitcnt lgkmcnt(1)
  v_mfma_f32_32x32x16_bf16 v[64:79], v[248:251], v[32:35], v[64:79]
  v_mov_b32 v21, s59
  s_mov_b64 exec, 1
  buffer_store_dword v21, v22, s[4:7], s63 offen sc1
  s_mov_b64 exec, -1
  v_mfma_f32_32x32x16_bf16 v[80:95], v[32:35], a[152:155], v[80:95]
  s_waitcnt lgkmcnt(0)
  v_mfma_f32_32x32x16_bf16 v[64:79], v[252:255], v[24:27], v[64:79]
  v_mfma_f32_32x32x16_bf16 v[80:95], v[24:27], a[156:159], v[80:95]
Lg1_epi:
  s_nop 7
  s_nop 3
  v_cvt_pk_bf16_f32 v36, v64, v65
  v_cvt_pk_bf16_f32 v37, v66, v67
  v_cvt_pk_bf16_f32 v38, v68, v69
  v_cvt_pk_bf16_f32 v39, v70, v71
  v_cvt_pk_bf16_f32 v40, v72, v73
  v_cvt_pk_bf16_f32 v41, v74, v75
  v_cvt_pk_bf16_f32 v42, v76, v77
  v_cvt_pk_bf16_f32 v43, v78, v79
  v_cvt_pk_bf16_f32 v44, v80, v81
  v_cvt_pk_bf16_f32 v45, v82, v83
  v_cvt_pk_bf16_f32 v48, v84, v85
  v_cvt_pk_bf16_f32 v49, v86, v87
  v_cvt_pk_bf16_f32 v46, v88, v89
  v_cvt_pk_bf16_f32 v47, v90, v91
  v_cvt_pk_bf16_f32 v50, v92, v93
  v_cvt_pk_bf16_f32 v51, v94, v95
  v_permlane32_swap_b32 v36, v38
  v_permlane32_swap_b32 v37, v39
  v_permlane32_swap_b32 v40, v42
  v_permlane32_swap_b32 v41, v43
  s_mov_b32 s42, s38
  s_mov_b32 s43, s39
  s_add_u32 s38, s38, 262144
  s_add_u32 s39, s39, 262144
  s_mov_b32 s57, s40
  s_mov_b32 s40, s41
  s_mov_b32 s41, s57
  s_add_u32 s35, s35, 1
  s_cmp_lt_u32 s35, 64
  s_cbranch_scc1 Lg1_seg
  buffer_store_dwordx4 v[44:47], v20, s[4:7], s43 offen sc1
  buffer_store_dwordx4 v[48:51], v20, s[4:7], s43 offen offset:512 sc1
  buffer_store_dwordx4 v[36:39], v19, s[4:7], s42 offen sc1
  buffer_store_dwordx4 v[40:43], v19, s[4:7], s42 offen offset:512 sc1
  s_waitcnt vmcnt(0)
  s_barrier
  s_cmp_lg_u32 s34, 0
  s_cbranch_scc1 Lg1_done
  v_mov_b32 v21, 64
  v_mov_b32 v22, 0
  s_mov_b64 exec, 1
  buffer_store_dword v21, v22, s[4:7], s36 offen sc1
  s_waitcnt vmcnt(0)
  s_mov_b64 exec, -1
Lg1_done:
  s_endpgm
Lrole_g2:
  s_cmp_eq_u32 s32, 0
  s_cselect_b32 s8, s68, s82
  s_cselect_b32 s9, s69, s83
  s_cselect_b32 s12, s70, s84
  s_cselect_b32 s13, s71, s85
  s_cselect_b32 s16, s72, s86
  s_cselect_b32 s17, s73, s87
  s_cselect_b32 s20, s74, s88
  s_cselect_b32 s21, s75, s89
  s_cselect_b32 s24, s64, s78
  s_cselect_b32 s25, s65, s79
  s_and_b32 s9, s9, 0xffff
  s_mov_b32 s10, 5242880
  s_mov_b32 s11, 0x20000
  s_and_b32 s13, s13, 0xffff
  s_mov_b32 s14, 5242880
  s_mov_b32 s15, 0x20000
  s_and_b32 s17, s17, 0xffff
  s_mov_b32 s18, 5242880
  s_mov_b32 s19, 0x20000
  s_and_b32 s21, s21, 0xffff
  s_mov_b32 s22, 5242880
  s_mov_b32 s23, 0x20000
  s_and_b32 s25, s25, 0xffff
  s_mov_b32 s26, 2621440
  s_mov_b32 s27, 0x20000
  s_mov_b32 s48, s92
  s_mov_b32 s49, s93
  s_mov_b32 s90, s98
  v_lshrrev_b32 v8, 6, v0
  s_nop 0
  v_readfirstlane_b32 s34, v8
  s_mov_b32 s55, 0x40000
  s_mov_b32 s56, 0
  s_nop 2
  s_lshl_b32 s57, s32, 5
  s_add_u32 s57, s57, s33
  s_lshl_b32 s57, s57, 7
  s_add_u32 s36, s57, 16384
  s_add_u32 s44, s57, 0
  s_add_u32 s45, s57, 8192
  s_mov_b32 s46, 0
  s_mov_b32 s47, 0
  s_mov_b32 s48, 0x3e028dc7
  v_and_b32 v8, 63, v0
  v_mov_b32 v9, 0x40000000
  v_mov_b32 v10, 0
  v_cmp_eq_u32 vcc, 0, v8
  s_nop 1
  v_cndmask_b32 v9, v9, v10, vcc
  buffer_store_dword v10, v9, s[4:7], s36 offen sc1
  s_waitcnt vmcnt(0)
  s_barrier
  s_cmp_lg_u32 s34, 0
  s_cbranch_scc1 Lskip_arr1
  v_mov_b32 v10, 1
  buffer_atomic_add v10, v9, s[28:31], 0 offen offset:64
Lskip_arr1:
  v_mov_b32 v23, 0
Linitw_3:
  buffer_load_dword v24, v23, s[28:31], 0 offen offset:64 sc1
  s_waitcnt vmcnt(0)
  v_readfirstlane_b32 s58, v24
  s_nop 3
  s_cmp_ge_u32 s58, 192
  s_cbranch_scc1 Linitw_3_ok
  s_cmp_lg_u32 s56, 0
  s_cbranch_scc1 Linitw_3_ok
  s_sub_u32 s55, s55, 1
  s_cbranch_scc0 Linitw_3
  s_mov_b32 s56, 1
Linitw_3_ok:
Lg2_first:
  buffer_load_dword v24, v23, s[4:7], s44 offen sc1
  s_waitcnt vmcnt(0)
  v_readfirstlane_b32 s58, v24
  s_nop 3
  s_cmp_ge_u32 s58, 1
  s_cbranch_scc1 Lg2_first_ok
  s_cmp_lg_u32 s56, 0
  s_cbranch_scc1 Lg2_first_ok
  s_sleep 8
  s_sub_u32 s55, s55, 1
  s_cbranch_scc0 Lg2_first
  s_mov_b32 s56, 1
Lg2_first_ok:
  v_and_b32 v20, 63, v0
  v_lshrrev_b32 v21, 4, v20
  v_and_b32 v22, 15, v20
  v_lshrrev_b32 v23, 2, v22
  v_and_b32 v24, 3, v22
  v_lshrrev_b32 v25, 1, v21
  v_lshl_add_u32 v23, v25, 3, v23
  v_lshlrev_b32 v23, 8, v23
  v_and_b32 v25, 1, v21
  v_lshl_add_u32 v23, v25, 5, v23
  v_lshl_add_u32 v23, v24, 3, v23
  s_lshl_b32 s57, s34, 6
  s_add_u32 s57, s57, 110592
  v_add_u32 v60, s57, v23
  v_lshlrev_b32 v23, 4, v22
  v_lshl_add_u32 v61, v21, 13, v23
  s_lshl_b32 s58, s33, 8
  s_lshl_b32 s57, s34, 16
  s_add_u32 s57, s57, s58
  s_add_u32 s57, s57, 0
  s_lshl_b32 s61, s34, 11
  s_add_u32 m0, s61, 110592
  s_nop 0
  buffer_load_dwordx4 v61, s[8:11], s57 offen nt lds
  s_lshl_b32 s57, s34, 16
  s_add_u32 s57, s57, s58
  s_add_u32 s57, s57, 32768
  s_lshl_b32 s61, s34, 11
  s_add_u32 m0, s61, 111616
  s_nop 0
  buffer_load_dwordx4 v61, s[8:11], s57 offen nt lds
  s_lshl_b32 s57, s34, 16
  s_add_u32 s57, s57, s58
  s_add_u32 s57, s57, 262144
  s_lshl_b32 s61, s34, 11
  s_add_u32 m0, s61, 118784
  s_nop 0
  buffer_load_dwordx4 v61, s[8:11], s57 offen nt lds
  s_lshl_b32 s57, s34, 16
  s_add_u32 s57, s57, s58
  s_add_u32 s57, s57, 294912
  s_lshl_b32 s61, s34, 11
  s_add_u32 m0, s61, 119808
  s_nop 0
  buffer_load_dwordx4 v61, s[8:11], s57 offen nt lds
  s_lshl_b32 s57, s34, 16
  s_add_u32 s57, s57, s58
  s_add_u32 s57, s57, 524288
  s_lshl_b32 s61, s34, 11
  s_add_u32 m0, s61, 126976
  s_nop 0
  buffer_load_dwordx4 v61, s[8:11], s57 offen nt lds
  s_lshl_b32 s57, s34, 16
  s_add_u32 s57, s57, s58
  s_add_u32 s57, s57, 557056
  s_lshl_b32 s61, s34, 11
  s_add_u32 m0, s61, 128000
  s_nop 0
  buffer_load_dwordx4 v61, s[8:11], s57 offen nt lds
  s_lshl_b32 s57, s34, 16
  s_add_u32 s57, s57, s58
  s_add_u32 s57, s57, 786432
  s_lshl_b32 s61, s34, 11
  s_add_u32 m0, s61, 135168
  s_nop 0
  buffer_load_dwordx4 v61, s[8:11], s57 offen nt lds
  s_lshl_b32 s57, s34, 16
  s_add_u32 s57, s57, s58
  s_add_u32 s57, s57, 819200
  s_lshl_b32 s61, s34, 11
  s_add_u32 m0, s61, 136192
  s_nop 0
  buffer_load_dwordx4 v61, s[8:11], s57 offen nt lds
  s_lshl_b32 s57, s34, 16
  s_add_u32 s57, s57, s58
  s_add_u32 s57, s57, 1048576
  s_lshl_b32 s61, s34, 11
  s_add_u32 m0, s61, 143360
  s_nop 0
  buffer_load_dwordx4 v61, s[8:11], s57 offen nt lds
  s_lshl_b32 s57, s34, 16
  s_add_u32 s57, s57, s58
  s_add_u32 s57, s57, 1081344
  s_lshl_b32 s61, s34, 11
  s_add_u32 m0, s61, 144384
  s_nop 0
  buffer_load_dwordx4 v61, s[8:11], s57 offen nt lds
  s_lshl_b32 s57, s34, 16
  s_add_u32 s57, s57, s58
  s_add_u32 s57, s57, 1310720
  s_lshl_b32 s61, s34, 11
  s_add_u32 m0, s61, 151552
  s_nop 0
  buffer_load_dwordx4 v61, s[8:11], s57 offen nt lds
  s_lshl_b32 s57, s34, 16
  s_add_u32 s57, s57, s58
  s_add_u32 s57, s57, 1343488
  s_lshl_b32 s61, s34, 11
  s_add_u32 m0, s61, 152576
  s_nop 0
  buffer_load_dwordx4 v61, s[8:11], s57 offen nt lds
  s_waitcnt vmcnt(10)
  s_barrier
  ds_read_b64_tr_b16 a[0:1], v60 offset:0
  ds_read_b64_tr_b16 a[2:3], v60 offset:1024
  ds_read_b64_tr_b16 a[4:5], v60 offset:4096
  ds_read_b64_tr_b16 a[6:7], v60 offset:5120
  s_waitcnt lgkmcnt(0)
  s_waitcnt vmcnt(8)
  s_barrier
  s_lshl_b32 s57, s34, 16
  s_add_u32 s57, s57, s58
  s_add_u32 s57, s57, 1572864
  s_lshl_b32 s61, s34, 11
  s_add_u32 m0, s61, 110592
  s_nop 0
  buffer_load_dwordx4 v61, s[8:11], s57 offen nt lds
  s_lshl_b32 s57, s34, 16
  s_add_u32 s57, s57, s58
  s_add_u32 s57, s57, 1605632
  s_lshl_b32 s61, s34, 11
  s_add_u32 m0, s61, 111616
  s_nop 0
  buffer_load_dwordx4 v61, s[8:11], s57 offen nt lds
  ds_read_b64_tr_b16 a[8:9], v60 offset:8192
  ds_read_b64_tr_b16 a[10:11], v60 offset:9216
  ds_read_b64_tr_b16 a[12:13], v60 offset:12288
  ds_read_b64_tr_b16 a[14:15], v60 offset:13312
  s_waitcnt lgkmcnt(0)
  s_waitcnt vmcnt(8)
  s_barrier
  s_lshl_b32 s57, s34, 16
  s_add_u32 s57, s57, s58
  s_add_u32 s57, s57, 1835008
  s_lshl_b32 s61, s34, 11
  s_add_u32 m0, s61, 118784
  s_nop 0
  buffer_load_dwordx4 v61, s[8:11], s57 offen nt lds
  s_lshl_b32 s57, s34, 16
  s_add_u32 s57, s57, s58
  s_add_u32 s57, s57, 1867776
  s_lshl_b32 s61, s34, 11
  s_add_u32 m0, s61, 119808
  s_nop 0
  buffer_load_dwordx4 v61, s[8:11], s57 offen nt lds
  ds_read_b64_tr_b16 a[16:17], v60 offset:16384
  ds_read_b64_tr_b16 a[18:19], v60 offset:17408
  ds_read_b64_tr_b16 a[20:21], v60 offset:20480
  ds_read_b64_tr_b16 a[22:23], v60 offset:21504
  s_waitcnt lgkmcnt(0)
  s_waitcnt vmcnt(8)
  s_barrier
  s_lshl_b32 s57, s34, 16
  s_add_u32 s57, s57, s58
  s_add_u32 s57, s57, 2097152
  s_lshl_b32 s61, s34, 11
  s_add_u32 m0, s61, 126976
  s_nop 0
  buffer_load_dwordx4 v61, s[8:11], s57 offen nt lds
  s_lshl_b32 s57, s34, 16
  s_add_u32 s57, s57, s58
  s_add_u32 s57, s57, 2129920
  s_lshl_b32 s61, s34, 11
  s_add_u32 m0, s61, 128000
  s_nop 0
  buffer_load_dwordx4 v61, s[8:11], s57 offen nt lds
  ds_read_b64_tr_b16 a[24:25], v60 offset:24576
  ds_read_b64_tr_b16 a[26:27], v60 offset:25600
  ds_read_b64_tr_b16 a[28:29], v60 offset:28672
  ds_read_b64_tr_b16 a[30:31], v60 offset:29696
  s_waitcnt lgkmcnt(0)
  s_waitcnt vmcnt(8)
  s_barrier
  s_lshl_b32 s57, s34, 16
  s_add_u32 s57, s57, s58
  s_add_u32 s57, s57, 2359296
  s_lshl_b32 s61, s34, 11
  s_add_u32 m0, s61, 135168
  s_nop 0
  buffer_load_dwordx4 v61, s[8:11], s57 offen nt lds
  s_lshl_b32 s57, s34, 16
  s_add_u32 s57, s57, s58
  s_add_u32 s57, s57, 2392064
  s_lshl_b32 s61, s34, 11
  s_add_u32 m0, s61, 136192
  s_nop 0
  buffer_load_dwordx4 v61, s[8:11], s57 offen nt lds
  ds_read_b64_tr_b16 a[32:33], v60 offset:32768
  ds_read_b64_tr_b16 a[34:35], v60 offset:33792
  ds_read_b64_tr_b16 a[36:37], v60 offset:36864
  ds_read_b64_tr_b16 a[38:39], v60 offset:37888
  s_waitcnt lgkmcnt(0)
  s_waitcnt vmcnt(8)
  s_barrier
  s_lshl_b32 s57, s34, 16
  s_add_u32 s57, s57, s58
  s_add_u32 s57, s57, 2621440
  s_lshl_b32 s61, s34, 11
  s_add_u32 m0, s61, 143360
  s_nop 0
  buffer_load_dwordx4 v61, s[8:11], s57 offen nt lds
  s_lshl_b32 s57, s34, 16
  s_add_u32 s57, s57, s58
  s_add_u32 s57, s57, 2654208
  s_lshl_b32 s61, s34, 11
  s_add_u32 m0, s61, 144384
  s_nop 0
  buffer_load_dwordx4 v61, s[8:11], s57 offen nt lds
  ds_read_b64_tr_b16 a[40:41], v60 offset:40960
  ds_read_b64_tr_b16 a[42:43], v60 offset:41984
  ds_read_b64_tr_b16 a[44:45], v60 offset:45056
  ds_read_b64_tr_b16 a[46:47], v60 offset:46080
  s_waitcnt lgkmcnt(0)
  s_waitcnt vmcnt(8)
  s_barrier
  s_lshl_b32 s57, s34, 16
  s_add_u32 s57, s57, s58
  s_add_u32 s57, s57, 2883584
  s_lshl_b32 s61, s34, 11
  s_add_u32 m0, s61, 151552
  s_nop 0
  buffer_load_dwordx4 v61, s[8:11], s57 offen nt lds
  s_lshl_b32 s57, s34, 16
  s_add_u32 s57, s57, s58
  s_add_u32 s57, s57, 2916352
  s_lshl_b32 s61, s34, 11
  s_add_u32 m0, s61, 152576
  s_nop 0
  buffer_load_dwordx4 v61, s[8:11], s57 offen nt lds
  ds_read_b64_tr_b16 a[48:49], v60 offset:0
  ds_read_b64_tr_b16 a[50:51], v60 offset:1024
  ds_read_b64_tr_b16 a[52:53], v60 offset:4096
  ds_read_b64_tr_b16 a[54:55], v60 offset:5120
  s_waitcnt lgkmcnt(0)
  s_waitcnt vmcnt(8)
  s_barrier
  s_lshl_b32 s57, s34, 16
  s_add_u32 s57, s57, s58
  s_add_u32 s57, s57, 3145728
  s_lshl_b32 s61, s34, 11
  s_add_u32 m0, s61, 110592
  s_nop 0
  buffer_load_dwordx4 v61, s[8:11], s57 offen nt lds
  s_lshl_b32 s57, s34, 16
  s_add_u32 s57, s57, s58
  s_add_u32 s57, s57, 3178496
  s_lshl_b32 s61, s34, 11
  s_add_u32 m0, s61, 111616
  s_nop 0
  buffer_load_dwordx4 v61, s[8:11], s57 offen nt lds
  ds_read_b64_tr_b16 a[56:57], v60 offset:8192
  ds_read_b64_tr_b16 a[58:59], v60 offset:9216
  ds_read_b64_tr_b16 a[60:61], v60 offset:12288
  ds_read_b64_tr_b16 a[62:63], v60 offset:13312
  s_waitcnt lgkmcnt(0)
  s_waitcnt vmcnt(8)
  s_barrier
  s_lshl_b32 s57, s34, 16
  s_add_u32 s57, s57, s58
  s_add_u32 s57, s57, 3407872
  s_lshl_b32 s61, s34, 11
  s_add_u32 m0, s61, 118784
  s_nop 0
  buffer_load_dwordx4 v61, s[8:11], s57 offen nt lds
  s_lshl_b32 s57, s34, 16
  s_add_u32 s57, s57, s58
  s_add_u32 s57, s57, 3440640
  s_lshl_b32 s61, s34, 11
  s_add_u32 m0, s61, 119808
  s_nop 0
  buffer_load_dwordx4 v61, s[8:11], s57 offen nt lds
  ds_read_b64_tr_b16 a[64:65], v60 offset:16384
  ds_read_b64_tr_b16 a[66:67], v60 offset:17408
  ds_read_b64_tr_b16 a[68:69], v60 offset:20480
  ds_read_b64_tr_b16 a[70:71], v60 offset:21504
  s_waitcnt lgkmcnt(0)
  s_waitcnt vmcnt(8)
  s_barrier
  s_lshl_b32 s57, s34, 16
  s_add_u32 s57, s57, s58
  s_add_u32 s57, s57, 3670016
  s_lshl_b32 s61, s34, 11
  s_add_u32 m0, s61, 126976
  s_nop 0
  buffer_load_dwordx4 v61, s[8:11], s57 offen nt lds
  s_lshl_b32 s57, s34, 16
  s_add_u32 s57, s57, s58
  s_add_u32 s57, s57, 3702784
  s_lshl_b32 s61, s34, 11
  s_add_u32 m0, s61, 128000
  s_nop 0
  buffer_load_dwordx4 v61, s[8:11], s57 offen nt lds
  ds_read_b64_tr_b16 a[72:73], v60 offset:24576
  ds_read_b64_tr_b16 a[74:75], v60 offset:25600
  ds_read_b64_tr_b16 a[76:77], v60 offset:28672
  ds_read_b64_tr_b16 a[78:79], v60 offset:29696
  s_waitcnt lgkmcnt(0)
  s_waitcnt vmcnt(8)
  s_barrier
  s_lshl_b32 s57, s34, 16
  s_add_u32 s57, s57, s58
  s_add_u32 s57, s57, 3932160
  s_lshl_b32 s61, s34, 11
  s_add_u32 m0, s61, 135168
  s_nop 0
  buffer_load_dwordx4 v61, s[8:11], s57 offen nt lds
  s_lshl_b32 s57, s34, 16
  s_add_u32 s57, s57, s58
  s_add_u32 s57, s57, 3964928
  s_lshl_b32 s61, s34, 11
  s_add_u32 m0, s61, 136192
  s_nop 0
  buffer_load_dwordx4 v61, s[8:11], s57 offen nt lds
  ds_read_b64_tr_b16 a[80:81], v60 offset:32768
  ds_read_b64_tr_b16 a[82:83], v60 offset:33792
  ds_read_b64_tr_b16 a[84:85], v60 offset:36864
  ds_read_b64_tr_b16 a[86:87], v60 offset:37888
  s_waitcnt lgkmcnt(0)
  s_waitcnt vmcnt(8)
  s_barrier
  s_lshl_b32 s57, s34, 16
  s_add_u32 s57, s57, s58
  s_add_u32 s57, s57, 4194304
  s_lshl_b32 s61, s34, 11
  s_add_u32 m0, s61, 143360
  s_nop 0
  buffer_load_dwordx4 v61, s[8:11], s57 offen nt lds
  s_lshl_b32 s57, s34, 16
  s_add_u32 s57, s57, s58
  s_add_u32 s57, s57, 4227072
  s_lshl_b32 s61, s34, 11
  s_add_u32 m0, s61, 144384
  s_nop 0
  buffer_load_dwordx4 v61, s[8:11], s57 offen nt lds
  ds_read_b64_tr_b16 a[88:89], v60 offset:40960
  ds_read_b64_tr_b16 a[90:91], v60 offset:41984
  ds_read_b64_tr_b16 a[92:93], v60 offset:45056
  ds_read_b64_tr_b16 a[94:95], v60 offset:46080
  s_waitcnt lgkmcnt(0)
  s_waitcnt vmcnt(8)
  s_barrier
  s_lshl_b32 s57, s34, 16
  s_add_u32 s57, s57, s58
  s_add_u32 s57, s57, 4456448
  s_lshl_b32 s61, s34, 11
  s_add_u32 m0, s61, 151552
  s_nop 0
  buffer_load_dwordx4 v61, s[8:11], s57 offen nt lds
  s_lshl_b32 s57, s34, 16
  s_add_u32 s57, s57, s58
  s_add_u32 s57, s57, 4489216
  s_lshl_b32 s61, s34, 11
  s_add_u32 m0, s61, 152576
  s_nop 0
  buffer_load_dwordx4 v61, s[8:11], s57 offen nt lds
  ds_read_b64_tr_b16 a[96:97], v60 offset:0
  ds_read_b64_tr_b16 a[98:99], v60 offset:1024
  ds_read_b64_tr_b16 a[100:101], v60 offset:4096
  ds_read_b64_tr_b16 a[102:103], v60 offset:5120
  s_waitcnt lgkmcnt(0)
  s_waitcnt vmcnt(8)
  s_barrier
  s_lshl_b32 s57, s34, 16
  s_add_u32 s57, s57, s58
  s_add_u32 s57, s57, 4718592
  s_lshl_b32 s61, s34, 11
  s_add_u32 m0, s61, 110592
  s_nop 0
  buffer_load_dwordx4 v61, s[8:11], s57 offen nt lds
  s_lshl_b32 s57, s34, 16
  s_add_u32 s57, s57, s58
  s_add_u32 s57, s57, 4751360
  s_lshl_b32 s61, s34, 11
  s_add_u32 m0, s61, 111616
  s_nop 0
  buffer_load_dwordx4 v61, s[8:11], s57 offen nt lds
  ds_read_b64_tr_b16 a[104:105], v60 offset:8192
  ds_read_b64_tr_b16 a[106:107], v60 offset:9216
  ds_read_b64_tr_b16 a[108:109], v60 offset:12288
  ds_read_b64_tr_b16 a[110:111], v60 offset:13312
  s_waitcnt lgkmcnt(0)
  s_waitcnt vmcnt(8)
  s_barrier
  s_lshl_b32 s57, s34, 16
  s_add_u32 s57, s57, s58
  s_add_u32 s57, s57, 4980736
  s_lshl_b32 s61, s34, 11
  s_add_u32 m0, s61, 118784
  s_nop 0
  buffer_load_dwordx4 v61, s[8:11], s57 offen nt lds
  s_lshl_b32 s57, s34, 16
  s_add_u32 s57, s57, s58
  s_add_u32 s57, s57, 5013504
  s_lshl_b32 s61, s34, 11
  s_add_u32 m0, s61, 119808
  s_nop 0
  buffer_load_dwordx4 v61, s[8:11], s57 offen nt lds
  ds_read_b64_tr_b16 a[112:113], v60 offset:16384
  ds_read_b64_tr_b16 a[114:115], v60 offset:17408
  ds_read_b64_tr_b16 a[116:117], v60 offset:20480
  ds_read_b64_tr_b16 a[118:119], v60 offset:21504
  s_waitcnt lgkmcnt(0)
  s_waitcnt vmcnt(8)
  s_barrier
  ds_read_b64_tr_b16 a[120:121], v60 offset:24576
  ds_read_b64_tr_b16 a[122:123], v60 offset:25600
  ds_read_b64_tr_b16 a[124:125], v60 offset:28672
  ds_read_b64_tr_b16 a[126:127], v60 offset:29696
  s_waitcnt lgkmcnt(0)
  s_waitcnt vmcnt(6)
  s_barrier
  ds_read_b64_tr_b16 a[128:129], v60 offset:32768
  ds_read_b64_tr_b16 a[130:131], v60 offset:33792
  ds_read_b64_tr_b16 a[132:133], v60 offset:36864
  ds_read_b64_tr_b16 a[134:135], v60 offset:37888
  s_waitcnt lgkmcnt(0)
  s_waitcnt vmcnt(4)
  s_barrier
  ds_read_b64_tr_b16 a[136:137], v60 offset:40960
  ds_read_b64_tr_b16 a[138:139], v60 offset:41984
  ds_read_b64_tr_b16 a[140:141], v60 offset:45056
  ds_read_b64_tr_b16 a[142:143], v60 offset:46080
  s_waitcnt lgkmcnt(0)
  s_waitcnt vmcnt(2)
  s_barrier
  ds_read_b64_tr_b16 a[144:145], v60 offset:0
  ds_read_b64_tr_b16 a[146:147], v60 offset:1024
  ds_read_b64_tr_b16 a[148:149], v60 offset:4096
  ds_read_b64_tr_b16 a[150:151], v60 offset:5120
  s_waitcnt lgkmcnt(0)
  s_waitcnt vmcnt(0)
  s_barrier
  ds_read_b64_tr_b16 a[152:153], v60 offset:8192
  ds_read_b64_tr_b16 a[154:155], v60 offset:9216
  ds_read_b64_tr_b16 a[156:157], v60 offset:12288
  ds_read_b64_tr_b16 a[158:159], v60 offset:13312
  s_waitcnt lgkmcnt(0)
  s_barrier
  v_and_b32 v20, 63, v0
  v_lshlrev_b32 v0, 4, v20
  v_and_b32 v21, 31, v20
  v_lshrrev_b32 v22, 5, v20
  v_and_b32 v23, 15, v21
  v_xor_b32 v23, v23, v22
  v_lshlrev_b32 v23, 4, v23
  v_mul_u32_u24 v24, 1280, v21
  v_add_u32 v1, v24, v23
  v_xor_b32 v2, 32, v1
  v_xor_b32 v3, 64, v1
  v_xor_b32 v4, 96, v1
  v_xor_b32 v5, 128, v1
  v_xor_b32 v6, 160, v1
  v_xor_b32 v7, 192, v1
  v_xor_b32 v8, 224, v1
  s_lshl_b32 s57, s34, 3
  v_add_u32 v21, 0, v20
  v_mul_u32_u24 v22, 52429, v21
  v_lshrrev_b32 v22, 22, v22
  v_mul_u32_u24 v23, 80, v22
  v_sub_u32 v23, v21, v23
  v_add_u32 v22, s57, v22
  v_and_b32 v24, 15, v22
  v_and_b32 v25, 15, v23
  v_xor_b32 v24, v24, v25
  v_and_b32 v25, 0x70, v23
  v_add_u32 v24, v24, v25
  v_lshlrev_b32 v24, 4, v24
  v_mul_u32_u24 v25, 1280, v22
  v_add_u32 v9, v24, v25
  v_add_u32 v21, 64, v20
  v_mul_u32_u24 v22, 52429, v21
  v_lshrrev_b32 v22, 22, v22
  v_mul_u32_u24 v23, 80, v22
  v_sub_u32 v23, v21, v23
  v_add_u32 v22, s57, v22
  v_and_b32 v24, 15, v22
  v_and_b32 v25, 15, v23
  v_xor_b32 v24, v24, v25
  v_and_b32 v25, 0x70, v23
  v_add_u32 v24, v24, v25
  v_lshlrev_b32 v24, 4, v24
  v_mul_u32_u24 v25, 1280, v22
  v_add_u32 v10, v24, v25
  v_add_u32 v21, 128, v20
  v_mul_u32_u24 v22, 52429, v21
  v_lshrrev_b32 v22, 22, v22
  v_mul_u32_u24 v23, 80, v22
  v_sub_u32 v23, v21, v23
  v_add_u32 v22, s57, v22
  v_and_b32 v24, 15, v22
  v_and_b32 v25, 15, v23
  v_xor_b32 v24, v24, v25
  v_and_b32 v25, 0x70, v23
  v_add_u32 v24, v24, v25
  v_lshlrev_b32 v24, 4, v24
  v_mul_u32_u24 v25, 1280, v22
  v_add_u32 v11, v24, v25
  v_add_u32 v21, 192, v20
  v_mul_u32_u24 v22, 52429, v21
  v_lshrrev_b32 v22, 22, v22
  v_mul_u32_u24 v23, 80, v22
  v_sub_u32 v23, v21, v23
  v_add_u32 v22, s57, v22
  v_and_b32 v24, 15, v22
  v_and_b32 v25, 15, v23
  v_xor_b32 v24, v24, v25
  v_and_b32 v25, 0x70, v23
  v_add_u32 v24, v24, v25
  v_lshlrev_b32 v24, 4, v24
  v_mul_u32_u24 v25, 1280, v22
  v_add_u32 v12, v24, v25
  v_add_u32 v21, 256, v20
  v_mul_u32_u24 v22, 52429, v21
  v_lshrrev_b32 v22, 22, v22
  v_mul_u32_u24 v23, 80, v22
  v_sub_u32 v23, v21, v23
  v_add_u32 v22, s57, v22
  v_and_b32 v24, 15, v22
  v_and_b32 v25, 15, v23
  v_xor_b32 v24, v24, v25
  v_and_b32 v25, 0x70, v23
  v_add_u32 v24, v24, v25
  v_lshlrev_b32 v24, 4, v24
  v_mul_u32_u24 v25, 1280, v22
  v_add_u32 v13, v24, v25
  v_add_u32 v21, 320, v20
  v_mul_u32_u24 v22, 52429, v21
  v_lshrrev_b32 v22, 22, v22
  v_mul_u32_u24 v23, 80, v22
  v_sub_u32 v23, v21, v23
  v_add_u32 v22, s57, v22
  v_and_b32 v24, 15, v22
  v_and_b32 v25, 15, v23
  v_xor_b32 v24, v24, v25
  v_and_b32 v25, 0x70, v23
  v_add_u32 v24, v24, v25
  v_lshlrev_b32 v24, 4, v24
  v_mul_u32_u24 v25, 1280, v22
  v_add_u32 v14, v24, v25
  v_add_u32 v21, 384, v20
  v_mul_u32_u24 v22, 52429, v21
  v_lshrrev_b32 v22, 22, v22
  v_mul_u32_u24 v23, 80, v22
  v_sub_u32 v23, v21, v23
  v_add_u32 v22, s57, v22
  v_and_b32 v24, 15, v22
  v_and_b32 v25, 15, v23
  v_xor_b32 v24, v24, v25
  v_and_b32 v25, 0x70, v23
  v_add_u32 v24, v24, v25
  v_lshlrev_b32 v24, 4, v24
  v_mul_u32_u24 v25, 1280, v22
  v_add_u32 v15, v24, v25
  v_add_u32 v21, 448, v20
  v_mul_u32_u24 v22, 52429, v21
  v_lshrrev_b32 v22, 22, v22
  v_mul_u32_u24 v23, 80, v22
  v_sub_u32 v23, v21, v23
  v_add_u32 v22, s57, v22
  v_and_b32 v24, 15, v22
  v_and_b32 v25, 15, v23
  v_xor_b32 v24, v24, v25
  v_and_b32 v25, 0x70, v23
  v_add_u32 v24, v24, v25
  v_lshlrev_b32 v24, 4, v24
  v_mul_u32_u24 v25, 1280, v22
  v_add_u32 v16, v24, v25
  v_add_u32 v21, 512, v20
  v_mul_u32_u24 v22, 52429, v21
  v_lshrrev_b32 v22, 22, v22
  v_mul_u32_u24 v23, 80, v22
  v_sub_u32 v23, v21, v23
  v_add_u32 v22, s57, v22
  v_and_b32 v24, 15, v22
  v_and_b32 v25, 15, v23
  v_xor_b32 v24, v24, v25
  v_and_b32 v25, 0x70, v23
  v_add_u32 v24, v24, v25
  v_lshlrev_b32 v24, 4, v24
  v_mul_u32_u24 v25, 1280, v22
  v_add_u32 v17, v24, v25
  v_add_u32 v21, 576, v20
  v_mul_u32_u24 v22, 52429, v21
  v_lshrrev_b32 v22, 22, v22
  v_mul_u32_u24 v23, 80, v22
  v_sub_u32 v23, v21, v23
  v_add_u32 v22, s57, v22
  v_and_b32 v24, 15, v22
  v_and_b32 v25, 15, v23
  v_xor_b32 v24, v24, v25
  v_and_b32 v25, 0x70, v23
  v_add_u32 v24, v24, v25
  v_lshlrev_b32 v24, 4, v24
  v_mul_u32_u24 v25, 1280, v22
  v_add_u32 v18, v24, v25
  v_lshrrev_b32 v24, 4, v0
  v_and_b32 v25, 31, v24
  v_lshrrev_b32 v26, 5, v24
  v_lshrrev_b32 v27, 4, v25
  v_and_b32 v28, 15, v25
  v_lshlrev_b32 v27, 12, v27
  v_lshl_add_u32 v27, v28, 4, v27
  v_lshl_add_u32 v27, v26, 8, v27
  s_lshl_b32 s57, s34, 10
  s_add_u32 s57, s57, 81920
  v_add_u32 v19, s57, v27
  v_and_b32 v25, 15, v24
  v_lshrrev_b32 v26, 4, v24
  v_lshrrev_b32 v27, 2, v25
  v_and_b32 v28, 1, v27
  v_lshrrev_b32 v27, 1, v27
  v_lshl_add_u32 v27, v26, 2, v27
  v_lshlrev_b32 v29, 3, v28
  v_xor_b32 v27, v27, v29
  v_and_b32 v29, 1, v25
  v_lshl_add_u32 v28, v28, 1, v29
  v_lshl_add_u32 v27, v28, 4, v27
  v_lshlrev_b32 v20, 3, v27
  v_lshrrev_b32 v27, 1, v26
  v_lshlrev_b32 v27, 3, v27
  v_xor_b32 v27, v27, v25
  v_lshl_add_u32 v27, v26, 4, v27
  v_lshlrev_b32 v21, 3, v27
  s_and_b32 s57, s34, 1
  s_lshl_b32 s57, s57, 4
  v_add_u32 v27, s57, v25
  v_lshlrev_b32 v28, 2, v26
  v_sub_u32 v27, v27, v28
  v_cmp_le_i32 s[64:65], 0, v27
  v_cmp_le_i32 s[66:67], 1, v27
  v_cmp_le_i32 s[68:69], 2, v27
  v_cmp_le_i32 s[70:71], 3, v27
  v_cmp_le_i32 s[72:73], 16, v27
  v_cmp_le_i32 s[74:75], 17, v27
  v_cmp_le_i32 s[76:77], 18, v27
  v_cmp_le_i32 s[78:79], 19, v27
  s_lshl_b32 s57, s32, 11
  s_add_u32 s57, s57, s33
  s_lshl_b32 s40, s57, 12
  s_add_u32 s40, s40, 16777216
  s_lshl_b32 s57, s57, 13
  s_add_u32 s38, s57, 33554432
  s_add_u32 s39, s57, 67108864
  s_lshl_b32 s41, s32, 24
  s_add_u32 s41, s41, 100663296
  s_and_b32 s57, s34, 1
  s_lshl_b32 s57, s57, 17
  s_add_u32 s41, s41, s57
  s_lshl_b32 s57, s33, 12
  s_add_u32 s41, s41, s57
  s_lshr_b32 s57, s34, 1
  s_lshl_b32 s57, s57, 11
  s_add_u32 s41, s41, s57
  s_mov_b32 s37, 0
  s_mov_b32 s42, 0
  s_mov_b32 s43, 40960
  s_mov_b32 s35, 0
  v_mov_b32 v23, 0
  s_mul_i32 s61, s34, 10240
  s_add_u32 m0, s61, s42
  s_nop 0
  s_nop 0
  buffer_load_dwordx4 v9, s[24:27], s37 offen lds
  s_add_u32 m0, m0, 1024
  s_nop 0
  buffer_load_dwordx4 v10, s[24:27], s37 offen lds
  s_add_u32 m0, m0, 1024
  s_nop 0
  buffer_load_dwordx4 v11, s[24:27], s37 offen lds
  s_add_u32 m0, m0, 1024
  s_nop 0
  buffer_load_dwordx4 v12, s[24:27], s37 offen lds
  s_add_u32 m0, m0, 1024
  s_nop 0
  buffer_load_dwordx4 v13, s[24:27], s37 offen lds
  s_add_u32 m0, m0, 1024
  s_nop 0
  buffer_load_dwordx4 v14, s[24:27], s37 offen lds
  s_add_u32 m0, m0, 1024
  s_nop 0
  buffer_load_dwordx4 v15, s[24:27], s37 offen lds
  s_add_u32 m0, m0, 1024
  s_nop 0
  buffer_load_dwordx4 v16, s[24:27], s37 offen lds
  s_add_u32 m0, m0, 1024
  s_nop 0
  buffer_load_dwordx4 v17, s[24:27], s37 offen lds
  s_add_u32 m0, m0, 1024
  s_nop 0
  buffer_load_dwordx4 v18, s[24:27], s37 offen lds
  s_waitcnt vmcnt(0)
Lg2_seg:
  s_barrier
  s_add_u32 s59, s35, 1
  s_cmp_ge_u32 s46, s59
  s_cbranch_scc1 Lg2_g1ok
Lg2_g1:
  buffer_load_dword v24, v23, s[4:7], s44 offen sc1
  s_waitcnt vmcnt(0)
  s_nop 0
  v_readfirstlane_b32 s46, v24
  s_nop 3
  s_cmp_ge_u32 s46, s59
  s_cbranch_scc1 Lg2_g1ok
  s_cmp_lg_u32 s56, 0
  s_cbranch_scc1 Lg2_g1ok
  s_sub_u32 s55, s55, 1
  s_cbranch_scc0 Lg2_g1
  s_mov_b32 s56, 1
Lg2_g1ok:
  s_lshl_b32 s61, s34, 11
  s_add_u32 m0, s61, 90112
  s_add_u32 s62, s61, s38
  buffer_load_dwordx4 v0, s[4:7], s62 offen sc1 lds
  s_add_u32 m0, m0, 1024
  s_add_u32 s62, s62, 1024
  buffer_load_dwordx4 v0, s[4:7], s62 offen sc1 lds
  s_add_u32 m0, s61, 98304
  s_add_u32 s62, s61, s39
  buffer_load_dwordx4 v0, s[4:7], s62 offen sc1 lds
  s_add_u32 m0, m0, 1024
  s_add_u32 s62, s62, 1024
  buffer_load_dwordx4 v0, s[4:7], s62 offen sc1 lds
  s_add_u32 s59, s35, 2
  s_mov_b32 s50, 0
  s_cmp_ge_u32 s47, s59
  s_cbranch_scc0 Lg2_notearly
  s_mov_b32 s50, 1
  v_lshrrev_b32 v24, 2, v0
  s_lshl_b32 s61, s34, 9
  s_add_u32 m0, s61, 106496
  s_add_u32 s62, s61, s40
  buffer_load_dword v24, s[4:7], s62 offen sc1 lds
  s_add_u32 m0, m0, 256
  s_add_u32 s62, s62, 256
  buffer_load_dword v24, s[4:7], s62 offen sc1 lds
  s_lshr_b32 s61, s34, 1
  s_lshl_b32 s61, s61, 10
  s_add_u32 s62, s61, s40
  s_add_u32 s62, s62, 2048
  buffer_load_dwordx2 v[52:53], v21, s[4:7], s62 offen sc1
  buffer_load_dwordx2 v[54:55], v21, s[4:7], s62 offen offset:512 sc1
Lg2_notearly:
  s_add_u32 s37, s37, 40960
  s_mul_i32 s61, s34, 10240
  s_add_u32 s62, s61, s43
  s_cmp_eq_u32 s42, 0
  s_cbranch_scc0 Lg2_odd
  ds_read_b128 v[24:27], v1 offset:0
  ds_read_b128 v[28:31], v2 offset:0
  s_waitcnt lgkmcnt(1)
  v_mfma_f32_32x32x16_bf16 v[64:79], a[0:3], v[24:27], 0
  ds_read_b128 v[32:35], v3 offset:0
  s_waitcnt lgkmcnt(1)
  v_mfma_f32_32x32x16_bf16 v[64:79], a[4:7], v[28:31], v[64:79]
  ds_read_b128 v[24:27], v4 offset:0
  s_waitcnt lgkmcnt(1)
  v_mfma_f32_32x32x16_bf16 v[64:79], a[8:11], v[32:35], v[64:79]
  ds_read_b128 v[28:31], v5 offset:0
  s_waitcnt lgkmcnt(1)
  v_mfma_f32_32x32x16_bf16 v[64:79], a[12:15], v[24:27], v[64:79]
  ds_read_b128 v[32:35], v6 offset:0
  s_waitcnt lgkmcnt(1)
  v_mfma_f32_32x32x16_bf16 v[64:79], a[16:19], v[28:31], v[64:79]
  ds_read_b128 v[24:27], v7 offset:0
  s_waitcnt lgkmcnt(1)
  v_mfma_f32_32x32x16_bf16 v[64:79], a[20:23], v[32:35], v[64:79]
  ds_read_b128 v[28:31], v8 offset:0
  s_waitcnt lgkmcnt(1)
  v_mfma_f32_32x32x16_bf16 v[64:79], a[24:27], v[24:27], v[64:79]
  ds_read_b128 v[32:35], v1 offset:256
  s_waitcnt lgkmcnt(1)
  v_mfma_f32_32x32x16_bf16 v[64:79], a[28:31], v[28:31], v[64:79]
  ds_read_b128 v[24:27], v2 offset:256
  s_waitcnt lgkmcnt(1)
  v_mfma_f32_32x32x16_bf16 v[64:79], a[32:35], v[32:35], v[64:79]
  ds_read_b128 v[28:31], v3 offset:256
  s_waitcnt lgkmcnt(1)
  s_add_u32 m0, s62, 0
  v_mfma_f32_32x32x16_bf16 v[64:79], a[36:39], v[24:27], v[64:79]
  ds_read_b128 v[32:35], v4 offset:256
  buffer_load_dwordx4 v9, s[24:27], s37 offen lds
  s_waitcnt lgkmcnt(1)
  v_mfma_f32_32x32x16_bf16 v[64:79], a[40:43], v[28:31], v[64:79]
  ds_read_b128 v[24:27], v5 offset:256
  s_waitcnt lgkmcnt(1)
  v_mfma_f32_32x32x16_bf16 v[64:79], a[44:47], v[32:35], v[64:79]
  ds_read_b128 v[28:31], v6 offset:256
  s_waitcnt lgkmcnt(1)
  s_add_u32 m0, s62, 1024
  v_mfma_f32_32x32x16_bf16 v[64:79], a[48:51], v[24:27], v[64:79]
  ds_read_b128 v[32:35], v7 offset:256
  buffer_load_dwordx4 v10, s[24:27], s37 offen lds
  s_waitcnt lgkmcnt(1)
  v_mfma_f32_32x32x16_bf16 v[64:79], a[52:55], v[28:31], v[64:79]
  ds_read_b128 v[24:27], v8 offset:256
  s_waitcnt lgkmcnt(1)
  v_mfma_f32_32x32x16_bf16 v[64:79], a[56:59], v[32:35], v[64:79]
  ds_read_b128 v[28:31], v1 offset:512
  s_waitcnt lgkmcnt(1)
  s_add_u32 m0, s62, 2048
  v_mfma_f32_32x32x16_bf16 v[64:79], a[60:63], v[24:27], v[64:79]
  ds_read_b128 v[32:35], v2 offset:512
  buffer_load_dwordx4 v11, s[24:27], s37 offen lds
  s_waitcnt lgkmcnt(1)
  v_mfma_f32_32x32x16_bf16 v[64:79], a[64:67], v[28:31], v[64:79]
  ds_read_b128 v[24:27], v3 offset:512
  s_waitcnt lgkmcnt(1)
  v_mfma_f32_32x32x16_bf16 v[64:79], a[68:71], v[32:35], v[64:79]
  ds_read_b128 v[28:31], v4 offset:512
  s_waitcnt lgkmcnt(1)
  s_add_u32 m0, s62, 3072
  v_mfma_f32_32x32x16_bf16 v[64:79], a[72:75], v[24:27], v[64:79]
  ds_read_b128 v[32:35], v5 offset:512
  buffer_load_dwordx4 v12, s[24:27], s37 offen lds
  s_waitcnt lgkmcnt(1)
  v_mfma_f32_32x32x16_bf16 v[64:79], a[76:79], v[28:31], v[64:79]
  ds_read_b128 v[24:27], v6 offset:512
  s_waitcnt lgkmcnt(1)
  v_mfma_f32_32x32x16_bf16 v[64:79], a[80:83], v[32:35], v[64:79]
  ds_read_b128 v[28:31], v7 offset:512
  s_waitcnt lgkmcnt(1)
  s_add_u32 m0, s62, 4096
  v_mfma_f32_32x32x16_bf16 v[64:79], a[84:87], v[24:27], v[64:79]
  ds_read_b128 v[32:35], v8 offset:512
  buffer_load_dwordx4 v13, s[24:27], s37 offen lds
  s_waitcnt lgkmcnt(1)
  v_mfma_f32_32x32x16_bf16 v[64:79], a[88:91], v[28:31], v[64:79]
  ds_read_b128 v[24:27], v1 offset:768
  s_waitcnt lgkmcnt(1)
  v_mfma_f32_32x32x16_bf16 v[64:79], a[92:95], v[32:35], v[64:79]
  ds_read_b128 v[28:31], v2 offset:768
  s_waitcnt lgkmcnt(1)
  s_add_u32 m0, s62, 5120
  v_mfma_f32_32x32x16_bf16 v[64:79], a[96:99], v[24:27], v[64:79]
  ds_read_b128 v[32:35], v3 offset:768
  buffer_load_dwordx4 v14, s[24:27], s37 offen lds
  s_waitcnt lgkmcnt(1)
  v_mfma_f32_32x32x16_bf16 v[64:79], a[100:103], v[28:31], v[64:79]
  ds_read_b128 v[24:27], v4 offset:768
  s_waitcnt lgkmcnt(1)
  v_mfma_f32_32x32x16_bf16 v[64:79], a[104:107], v[32:35], v[64:79]
  ds_read_b128 v[28:31], v5 offset:768
  s_waitcnt lgkmcnt(1)
  s_add_u32 m0, s62, 6144
  v_mfma_f32_32x32x16_bf16 v[64:79], a[108:111], v[24:27], v[64:79]
  ds_read_b128 v[32:35], v6 offset:768
  buffer_load_dwordx4 v15, s[24:27], s37 offen lds
  s_waitcnt lgkmcnt(1)
  v_mfma_f32_32x32x16_bf16 v[64:79], a[112:115], v[28:31], v[64:79]
  ds_read_b128 v[24:27], v7 offset:768
  s_waitcnt lgkmcnt(1)
  v_mfma_f32_32x32x16_bf16 v[64:79], a[116:119], v[32:35], v[64:79]
  ds_read_b128 v[28:31], v8 offset:768
  s_waitcnt lgkmcnt(1)
  s_add_u32 m0, s62, 7168
  v_mfma_f32_32x32x16_bf16 v[64:79], a[120:123], v[24:27], v[64:79]
  ds_read_b128 v[32:35], v1 offset:1024
  buffer_load_dwordx4 v16, s[24:27], s37 offen lds
  s_waitcnt lgkmcnt(1)
  v_mfma_f32_32x32x16_bf16 v[64:79], a[124:127], v[28:31], v[64:79]
  ds_read_b128 v[24:27], v2 offset:1024
  s_waitcnt lgkmcnt(1)
  v_mfma_f32_32x32x16_bf16 v[64:79], a[128:131], v[32:35], v[64:79]
  ds_read_b128 v[28:31], v3 offset:1024
  s_waitcnt lgkmcnt(1)
  s_add_u32 m0, s62, 8192
  v_mfma_f32_32x32x16_bf16 v[64:79], a[132:135], v[24:27], v[64:79]
  ds_read_b128 v[32:35], v4 offset:1024
  buffer_load_dwordx4 v17, s[24:27], s37 offen lds
  s_waitcnt lgkmcnt(1)
  v_mfma_f32_32x32x16_bf16 v[64:79], a[136:139], v[28:31], v[64:79]
  ds_read_b128 v[24:27], v5 offset:1024
  s_waitcnt lgkmcnt(1)
  v_mfma_f32_32x32x16_bf16 v[64:79], a[140:143], v[32:35], v[64:79]
  ds_read_b128 v[28:31], v6 offset:1024
  s_waitcnt lgkmcnt(1)
  s_add_u32 m0, s62, 9216
  v_mfma_f32_32x32x16_bf16 v[64:79], a[144:147], v[24:27], v[64:79]
  ds_read_b128 v[32:35], v7 offset:1024
  buffer_load_dwordx4 v18, s[24:27], s37 offen lds
  s_waitcnt lgkmcnt(1)
  v_mfma_f32_32x32x16_bf16 v[64:79], a[148:151], v[28:31], v[64:79]
  ds_read_b128 v[24:27], v8 offset:1024
  s_waitcnt lgkmcnt(1)
  v_mfma_f32_32x32x16_bf16 v[64:79], a[152:155], v[32:35], v[64:79]
  s_waitcnt lgkmcnt(0)
  v_mfma_f32_32x32x16_bf16 v[64:79], a[156:159], v[24:27], v[64:79]
  s_branch Lg2_att
Lg2_odd:
  ds_read_b128 v[24:27], v1 offset:40960
  ds_read_b128 v[28:31], v2 offset:40960
  s_waitcnt lgkmcnt(1)
  v_mfma_f32_32x32x16_bf16 v[64:79], a[0:3], v[24:27], 0
  ds_read_b128 v[32:35], v3 offset:40960
  s_waitcnt lgkmcnt(1)
  v_mfma_f32_32x32x16_bf16 v[64:79], a[4:7], v[28:31], v[64:79]
  ds_read_b128 v[24:27], v4 offset:40960
  s_waitcnt lgkmcnt(1)
  v_mfma_f32_32x32x16_bf16 v[64:79], a[8:11], v[32:35], v[64:79]
  ds_read_b128 v[28:31], v5 offset:40960
  s_waitcnt lgkmcnt(1)
  v_mfma_f32_32x32x16_bf16 v[64:79], a[12:15], v[24:27], v[64:79]
  ds_read_b128 v[32:35], v6 offset:40960
  s_waitcnt lgkmcnt(1)
  v_mfma_f32_32x32x16_bf16 v[64:79], a[16:19], v[28:31], v[64:79]
  ds_read_b128 v[24:27], v7 offset:40960
  s_waitcnt lgkmcnt(1)
  v_mfma_f32_32x32x16_bf16 v[64:79], a[20:23], v[32:35], v[64:79]
  ds_read_b128 v[28:31], v8 offset:40960
  s_waitcnt lgkmcnt(1)
  v_mfma_f32_32x32x16_bf16 v[64:79], a[24:27], v[24:27], v[64:79]
  ds_read_b128 v[32:35], v1 offset:41216
  s_waitcnt lgkmcnt(1)
  v_mfma_f32_32x32x16_bf16 v[64:79], a[28:31], v[28:31], v[64:79]
  ds_read_b128 v[24:27], v2 offset:41216
  s_waitcnt lgkmcnt(1)
  v_mfma_f32_32x32x16_bf16 v[64:79], a[32:35], v[32:35], v[64:79]
  ds_read_b128 v[28:31], v3 offset:41216
  s_waitcnt lgkmcnt(1)
  s_add_u32 m0, s62, 0
  v_mfma_f32_32x32x16_bf16 v[64:79], a[36:39], v[24:27], v[64:79]
  ds_read_b128 v[32:35], v4 offset:41216
  buffer_load_dwordx4 v9, s[24:27], s37 offen lds
  s_waitcnt lgkmcnt(1)
  v_mfma_f32_32x32x16_bf16 v[64:79], a[40:43], v[28:31], v[64:79]
  ds_read_b128 v[24:27], v5 offset:41216
  s_waitcnt lgkmcnt(1)
  v_mfma_f32_32x32x16_bf16 v[64:79], a[44:47], v[32:35], v[64:79]
  ds_read_b128 v[28:31], v6 offset:41216
  s_waitcnt lgkmcnt(1)
  s_add_u32 m0, s62, 1024
  v_mfma_f32_32x32x16_bf16 v[64:79], a[48:51], v[24:27], v[64:79]
  ds_read_b128 v[32:35], v7 offset:41216
  buffer_load_dwordx4 v10, s[24:27], s37 offen lds
  s_waitcnt lgkmcnt(1)
  v_mfma_f32_32x32x16_bf16 v[64:79], a[52:55], v[28:31], v[64:79]
  ds_read_b128 v[24:27], v8 offset:41216
  s_waitcnt lgkmcnt(1)
  v_mfma_f32_32x32x16_bf16 v[64:79], a[56:59], v[32:35], v[64:79]
  ds_read_b128 v[28:31], v1 offset:41472
  s_waitcnt lgkmcnt(1)
  s_add_u32 m0, s62, 2048
  v_mfma_f32_32x32x16_bf16 v[64:79], a[60:63], v[24:27], v[64:79]
  ds_read_b128 v[32:35], v2 offset:41472
  buffer_load_dwordx4 v11, s[24:27], s37 offen lds
  s_waitcnt lgkmcnt(1)
  v_mfma_f32_32x32x16_bf16 v[64:79], a[64:67], v[28:31], v[64:79]
  ds_read_b128 v[24:27], v3 offset:41472
  s_waitcnt lgkmcnt(1)
  v_mfma_f32_32x32x16_bf16 v[64:79], a[68:71], v[32:35], v[64:79]
  ds_read_b128 v[28:31], v4 offset:41472
  s_waitcnt lgkmcnt(1)
  s_add_u32 m0, s62, 3072
  v_mfma_f32_32x32x16_bf16 v[64:79], a[72:75], v[24:27], v[64:79]
  ds_read_b128 v[32:35], v5 offset:41472
  buffer_load_dwordx4 v12, s[24:27], s37 offen lds
  s_waitcnt lgkmcnt(1)
  v_mfma_f32_32x32x16_bf16 v[64:79], a[76:79], v[28:31], v[64:79]
  ds_read_b128 v[24:27], v6 offset:41472
  s_waitcnt lgkmcnt(1)
  v_mfma_f32_32x32x16_bf16 v[64:79], a[80:83], v[32:35], v[64:79]
  ds_read_b128 v[28:31], v7 offset:41472
  s_waitcnt lgkmcnt(1)
  s_add_u32 m0, s62, 4096
  v_mfma_f32_32x32x16_bf16 v[64:79], a[84:87], v[24:27], v[64:79]
  ds_read_b128 v[32:35], v8 offset:41472
  buffer_load_dwordx4 v13, s[24:27], s37 offen lds
  s_waitcnt lgkmcnt(1)
  v_mfma_f32_32x32x16_bf16 v[64:79], a[88:91], v[28:31], v[64:79]
  ds_read_b128 v[24:27], v1 offset:41728
  s_waitcnt lgkmcnt(1)
  v_mfma_f32_32x32x16_bf16 v[64:79], a[92:95], v[32:35], v[64:79]
  ds_read_b128 v[28:31], v2 offset:41728
  s_waitcnt lgkmcnt(1)
  s_add_u32 m0, s62, 5120
  v_mfma_f32_32x32x16_bf16 v[64:79], a[96:99], v[24:27], v[64:79]
  ds_read_b128 v[32:35], v3 offset:41728
  buffer_load_dwordx4 v14, s[24:27], s37 offen lds
  s_waitcnt lgkmcnt(1)
  v_mfma_f32_32x32x16_bf16 v[64:79], a[100:103], v[28:31], v[64:79]
  ds_read_b128 v[24:27], v4 offset:41728
  s_waitcnt lgkmcnt(1)
  v_mfma_f32_32x32x16_bf16 v[64:79], a[104:107], v[32:35], v[64:79]
  ds_read_b128 v[28:31], v5 offset:41728
  s_waitcnt lgkmcnt(1)
  s_add_u32 m0, s62, 6144
  v_mfma_f32_32x32x16_bf16 v[64:79], a[108:111], v[24:27], v[64:79]
  ds_read_b128 v[32:35], v6 offset:41728
  buffer_load_dwordx4 v15, s[24:27], s37 offen lds
  s_waitcnt lgkmcnt(1)
  v_mfma_f32_32x32x16_bf16 v[64:79], a[112:115], v[28:31], v[64:79]
  ds_read_b128 v[24:27], v7 offset:41728
  s_waitcnt lgkmcnt(1)
  v_mfma_f32_32x32x16_bf16 v[64:79], a[116:119], v[32:35], v[64:79]
  ds_read_b128 v[28:31], v8 offset:41728
  s_waitcnt lgkmcnt(1)
  s_add_u32 m0, s62, 7168
  v_mfma_f32_32x32x16_bf16 v[64:79], a[120:123], v[24:27], v[64:79]
  ds_read_b128 v[32:35], v1 offset:41984
  buffer_load_dwordx4 v16, s[24:27], s37 offen lds
  s_waitcnt lgkmcnt(1)
  v_mfma_f32_32x32x16_bf16 v[64:79], a[124:127], v[28:31], v[64:79]
  ds_read_b128 v[24:27], v2 offset:41984
  s_waitcnt lgkmcnt(1)
  v_mfma_f32_32x32x16_bf16 v[64:79], a[128:131], v[32:35], v[64:79]
  ds_read_b128 v[28:31], v3 offset:41984
  s_waitcnt lgkmcnt(1)
  s_add_u32 m0, s62, 8192
  v_mfma_f32_32x32x16_bf16 v[64:79], a[132:135], v[24:27], v[64:79]
  ds_read_b128 v[32:35], v4 offset:41984
  buffer_load_dwordx4 v17, s[24:27], s37 offen lds
  s_waitcnt lgkmcnt(1)
  v_mfma_f32_32x32x16_bf16 v[64:79], a[136:139], v[28:31], v[64:79]
  ds_read_b128 v[24:27], v5 offset:41984
  s_waitcnt lgkmcnt(1)
  v_mfma_f32_32x32x16_bf16 v[64:79], a[140:143], v[32:35], v[64:79]
  ds_read_b128 v[28:31], v6 offset:41984
  s_waitcnt lgkmcnt(1)
  s_add_u32 m0, s62, 9216
  v_mfma_f32_32x32x16_bf16 v[64:79], a[144:147], v[24:27], v[64:79]
  ds_read_b128 v[32:35], v7 offset:41984
  buffer_load_dwordx4 v18, s[24:27], s37 offen lds
  s_waitcnt lgkmcnt(1)
  v_mfma_f32_32x32x16_bf16 v[64:79], a[148:151], v[28:31], v[64:79]
  ds_read_b128 v[24:27], v8 offset:41984
  s_waitcnt lgkmcnt(1)
  v_mfma_f32_32x32x16_bf16 v[64:79], a[152:155], v[32:35], v[64:79]
  s_waitcnt lgkmcnt(0)
  v_mfma_f32_32x32x16_bf16 v[64:79], a[156:159], v[24:27], v[64:79]
Lg2_att:
  s_cmp_lg_u32 s50, 0
  s_cbranch_scc1 Lg2_kmdone
  s_add_u32 s59, s35, 2
  s_cmp_ge_u32 s47, s59
  s_cbranch_scc1 Lg2_chok
Lg2_ch:
  buffer_load_dwordx4 v[24:27], v23, s[4:7], s45 offen sc1
  s_waitcnt vmcnt(0)
  v_min_u32 v24, v24, v25
  v_min_u32 v26, v26, v27
  v_min_u32 v24, v24, v26
  s_nop 0
  v_readfirstlane_b32 s47, v24
  s_nop 3
  s_cmp_ge_u32 s47, s59
  s_cbranch_scc1 Lg2_chok
  s_cmp_lg_u32 s56, 0
  s_cbranch_scc1 Lg2_chok
  s_sub_u32 s55, s55, 1
  s_cbranch_scc0 Lg2_ch
  s_mov_b32 s56, 1
Lg2_chok:
  v_lshrrev_b32 v24, 2, v0
  s_lshl_b32 s61, s34, 9
  s_add_u32 m0, s61, 106496
  s_add_u32 s62, s61, s40
  buffer_load_dword v24, s[4:7], s62 offen sc1 lds
  s_add_u32 m0, m0, 256
  s_add_u32 s62, s62, 256
  buffer_load_dword v24, s[4:7], s62 offen sc1 lds
  s_lshr_b32 s61, s34, 1
  s_lshl_b32 s61, s61, 10
  s_add_u32 s62, s61, s40
  s_add_u32 s62, s62, 2048
  buffer_load_dwordx2 v[52:53], v21, s[4:7], s62 offen sc1
  buffer_load_dwordx2 v[54:55], v21, s[4:7], s62 offen offset:512 sc1
Lg2_kmdone:
  s_nop 4
  v_cvt_pk_bf16_f32 v36, v64, v65
  v_cvt_pk_bf16_f32 v37, v66, v67
  v_cvt_pk_bf16_f32 v38, v68, v69
  v_cvt_pk_bf16_f32 v39, v70, v71
  v_cvt_pk_bf16_f32 v40, v72, v73
  v_cvt_pk_bf16_f32 v41, v74, v75
  v_cvt_pk_bf16_f32 v42, v76, v77
  v_cvt_pk_bf16_f32 v43, v78, v79
  s_nop 1
  v_permlane32_swap_b32 v36, v38
  v_permlane32_swap_b32 v37, v39
  v_permlane32_swap_b32 v40, v42
  v_permlane32_swap_b32 v41, v43
  ds_write_b128 v19, v[36:39]
  ds_write_b128 v19, v[40:43] offset:512
  s_waitcnt vmcnt(0) lgkmcnt(0)
  s_barrier
  s_cmp_lg_u32 s34, 0
  s_cbranch_scc1 Lg2_noflag
  v_mov_b32 v24, s35
  s_mov_b64 exec, 1
  buffer_store_dword v24, v23, s[4:7], s36 offen sc1
  s_mov_b64 exec, -1
Lg2_noflag:
  s_and_b32 s61, s34, 1
  s_lshl_b32 s61, s61, 12
  s_add_u32 s61, s61, 81920
  v_add_u32 v24, s61, v0
  v_add_u32 v26, 90112, v0
  ds_read_b128 v[64:67], v24 offset:0
  ds_read_b128 v[80:83], v26 offset:0
  ds_read_b128 v[96:99], v26 offset:4096
  ds_read_b128 v[68:71], v24 offset:1024
  ds_read_b128 v[84:87], v26 offset:1024
  ds_read_b128 v[100:103], v26 offset:5120
  ds_read_b128 v[72:75], v24 offset:2048
  ds_read_b128 v[88:91], v26 offset:2048
  ds_read_b128 v[104:107], v26 offset:6144
  ds_read_b128 v[76:79], v24 offset:3072
  ds_read_b128 v[92:95], v26 offset:3072
  ds_read_b128 v[108:111], v26 offset:7168
  v_add_u32 v25, 106496, v20
  ds_read_b64_tr_b16 v[112:113], v25 offset:0
  ds_read_b64_tr_b16 v[114:115], v25 offset:16
  ds_read_b64_tr_b16 v[116:117], v25 offset:512
  ds_read_b64_tr_b16 v[118:119], v25 offset:528
  ds_read_b64_tr_b16 v[120:121], v25 offset:1024
  ds_read_b64_tr_b16 v[122:123], v25 offset:1040
  ds_read_b64_tr_b16 v[124:125], v25 offset:1536
  ds_read_b64_tr_b16 v[126:127], v25 offset:1552
  s_waitcnt lgkmcnt(0)
  v_mfma_f32_16x16x32_bf16 v[132:135], v[80:83], v[64:67], 0
  v_mfma_f32_16x16x32_bf16 v[136:139], v[96:99], v[64:67], 0
  v_mfma_f32_16x16x32_bf16 v[128:131], v[112:115], v[64:67], 0
  v_mfma_f32_16x16x32_bf16 v[132:135], v[84:87], v[68:71], v[132:135]
  v_mfma_f32_16x16x32_bf16 v[136:139], v[100:103], v[68:71], v[136:139]
  v_mfma_f32_16x16x32_bf16 v[128:131], v[116:119], v[68:71], v[128:131]
  v_mfma_f32_16x16x32_bf16 v[132:135], v[88:91], v[72:75], v[132:135]
  v_mfma_f32_16x16x32_bf16 v[136:139], v[104:107], v[72:75], v[136:139]
  v_mfma_f32_16x16x32_bf16 v[128:131], v[120:123], v[72:75], v[128:131]
  v_mfma_f32_16x16x32_bf16 v[132:135], v[92:95], v[76:79], v[132:135]
  v_mfma_f32_16x16x32_bf16 v[136:139], v[108:111], v[76:79], v[136:139]
  v_mfma_f32_16x16x32_bf16 v[128:131], v[124:127], v[76:79], v[128:131]
  s_lshr_b32 s61, s34, 1
  s_lshl_b32 s61, s61, 12
  s_add_u32 s61, s61, 98304
  v_add_u32 v24, s61, v0
  ds_read_b128 v[80:83], v24 offset:0
  ds_read_b128 v[84:87], v24 offset:1024
  ds_read_b128 v[88:91], v24 offset:2048
  ds_read_b128 v[92:95], v24 offset:3072
  v_mov_b32 v96, 0
  v_mov_b32 v100, 0
  v_mov_b32 v97, 0
  v_mov_b32 v101, 0
  v_mov_b32 v98, 0
  v_mov_b32 v102, 0
  v_mov_b32 v99, 0
  v_mov_b32 v103, 0
  s_nop 1
  v_mov_b32_dpp v96, v52 quad_perm:[0,1,2,3] row_mask:0x3 bank_mask:0xf
  v_mov_b32_dpp v100, v52 quad_perm:[0,1,2,3] row_mask:0xc bank_mask:0xf
  v_mov_b32_dpp v97, v53 quad_perm:[0,1,2,3] row_mask:0x3 bank_mask:0xf
  v_mov_b32_dpp v101, v53 quad_perm:[0,1,2,3] row_mask:0xc bank_mask:0xf
  v_mov_b32_dpp v98, v54 quad_perm:[0,1,2,3] row_mask:0x3 bank_mask:0xf
  v_mov_b32_dpp v102, v54 quad_perm:[0,1,2,3] row_mask:0xc bank_mask:0xf
  v_mov_b32_dpp v99, v55 quad_perm:[0,1,2,3] row_mask:0x3 bank_mask:0xf
  v_mov_b32_dpp v103, v55 quad_perm:[0,1,2,3] row_mask:0xc bank_mask:0xf
  v_mov_b32 v26, 0xf149f2ca
  v_cndmask_b32 v132, v26, v132, s[64:65]
  v_cndmask_b32 v133, v26, v133, s[66:67]
  v_cndmask_b32 v134, v26, v134, s[68:69]
  v_cndmask_b32 v135, v26, v135, s[70:71]
  v_cndmask_b32 v136, v26, v136, s[72:73]
  v_cndmask_b32 v137, v26, v137, s[74:75]
  v_cndmask_b32 v138, v26, v138, s[76:77]
  v_cndmask_b32 v139, v26, v139, s[78:79]
  v_max3_f32 v28, v132, v133, v134
  v_max3_f32 v28, v28, v135, v136
  v_max3_f32 v28, v28, v137, v138
  v_max3_f32 v28, v28, v139, v128
  v_max3_f32 v28, v28, v129, v130
  v_max_f32 v28, v28, v131
  v_mov_b32 v29, v28
  s_nop 1
  v_permlane32_swap_b32 v28, v29
  v_max_f32 v28, v28, v29
  v_mov_b32 v29, v28
  s_nop 1
  v_permlane16_swap_b32 v28, v29
  v_max_f32 v28, v28, v29
  v_mul_f32 v28, s48, v28
  v_fma_f32 v132, v132, s48, -v28
  v_fma_f32 v133, v133, s48, -v28
  v_fma_f32 v134, v134, s48, -v28
  v_fma_f32 v135, v135, s48, -v28
  v_fma_f32 v136, v136, s48, -v28
  v_fma_f32 v137, v137, s48, -v28
  v_fma_f32 v138, v138, s48, -v28
  v_fma_f32 v139, v139, s48, -v28
  v_fma_f32 v128, v128, s48, -v28
  v_fma_f32 v129, v129, s48, -v28
  v_fma_f32 v130, v130, s48, -v28
  v_fma_f32 v131, v131, s48, -v28
  v_exp_f32 v132, v132
  v_exp_f32 v133, v133
  v_exp_f32 v134, v134
  v_exp_f32 v135, v135
  v_exp_f32 v136, v136
  v_exp_f32 v137, v137
  v_exp_f32 v138, v138
  v_exp_f32 v139, v139
  v_exp_f32 v128, v128
  v_exp_f32 v129, v129
  v_exp_f32 v130, v130
  v_exp_f32 v131, v131
  s_nop 0
  v_cvt_pk_bf16_f32 v104, v132, v133
  v_cvt_pk_bf16_f32 v105, v134, v135
  v_cvt_pk_bf16_f32 v106, v136, v137
  v_cvt_pk_bf16_f32 v107, v138, v139
  v_cvt_pk_bf16_f32 v108, v128, v129
  v_cvt_pk_bf16_f32 v109, v130, v131
  v_add_f32 v132, v132, v133
  v_add_f32 v134, v134, v135
  v_add_f32 v136, v136, v137
  v_add_f32 v138, v138, v139
  v_add_f32 v128, v128, v129
  v_add_f32 v130, v130, v131
  v_add_f32 v132, v132, v134
  v_add_f32 v136, v136, v138
  v_add_f32 v128, v128, v130
  v_add_f32 v28, v132, v136
  s_nop 1
  v_add_f32_dpp v28, v128, v28 quad_perm:[0,1,2,3] row_mask:0x3 bank_mask:0xf
  v_mov_b32 v29, v28
  s_nop 1
  v_permlane32_swap_b32 v28, v29
  v_add_f32 v28, v28, v29
  v_mov_b32 v29, v28
  s_nop 1
  v_permlane16_swap_b32 v28, v29
  v_add_f32 v28, v28, v29
  v_rcp_f32 v28, v28
  s_waitcnt lgkmcnt(0)
  v_mfma_f32_16x16x32_bf16 v[112:115], v[80:83], v[104:107], 0
  v_mfma_f32_16x16x32_bf16 v[116:119], v[84:87], v[104:107], 0
  v_mfma_f32_16x16x32_bf16 v[120:123], v[88:91], v[104:107], 0
  v_mfma_f32_16x16x32_bf16 v[124:127], v[92:95], v[104:107], 0
  v_mfma_f32_16x16x16_bf16 v[112:115], v[96:97], v[108:109], v[112:115]
  v_mfma_f32_16x16x16_bf16 v[116:119], v[100:101], v[108:109], v[116:119]
  v_mfma_f32_16x16x16_bf16 v[120:123], v[98:99], v[108:109], v[120:123]
  v_mfma_f32_16x16x16_bf16 v[124:127], v[102:103], v[108:109], v[124:127]
  s_nop 7
  v_mul_f32 v112, v112, v28
  v_mul_f32 v113, v113, v28
  v_mul_f32 v114, v114, v28
  v_mul_f32 v115, v115, v28
  v_mul_f32 v116, v116, v28
  v_mul_f32 v117, v117, v28
  v_mul_f32 v118, v118, v28
  v_mul_f32 v119, v119, v28
  v_mul_f32 v120, v120, v28
  v_mul_f32 v121, v121, v28
  v_mul_f32 v122, v122, v28
  v_mul_f32 v123, v123, v28
  v_mul_f32 v124, v124, v28
  v_mul_f32 v125, v125, v28
  v_mul_f32 v126, v126, v28
  v_mul_f32 v127, v127, v28
  v_cvt_pk_bf16_f32 v36, v112, v116
  v_cvt_pk_bf16_f32 v37, v113, v117
  v_cvt_pk_bf16_f32 v38, v114, v118
  v_cvt_pk_bf16_f32 v39, v115, v119
  v_cvt_pk_bf16_f32 v40, v120, v124
  v_cvt_pk_bf16_f32 v41, v121, v125
  v_cvt_pk_bf16_f32 v42, v122, v126
  v_cvt_pk_bf16_f32 v43, v123, v127
  buffer_store_dwordx4 v[36:39], v0, s[4:7], s41 offen sc1
  buffer_store_dwordx4 v[40:43], v0, s[4:7], s41 offen offset:1024 sc1
  s_add_u32 s38, s38, 262144
  s_add_u32 s39, s39, 262144
  s_add_u32 s40, s40, 131072
  s_add_u32 s41, s41, 262144
  s_mov_b32 s57, s42
  s_mov_b32 s42, s43
  s_mov_b32 s43, s57
  s_add_u32 s35, s35, 1
  s_cmp_lt_u32 s35, 64
  s_cbranch_scc1 Lg2_seg
  s_waitcnt vmcnt(0)
  s_barrier
  s_cmp_lg_u32 s34, 0
  s_cbranch_scc1 Lg2_done
  v_mov_b32 v24, 64
  s_mov_b64 exec, 1
  buffer_store_dword v24, v23, s[4:7], s36 offen sc1
  s_waitcnt vmcnt(0)
  s_mov_b64 exec, -1
Lg2_done:
  s_endpgm
Lrole_g3:
  s_cmp_eq_u32 s32, 0
  s_cselect_b32 s8, s68, s82
  s_cselect_b32 s9, s69, s83
  s_cselect_b32 s12, s70, s84
  s_cselect_b32 s13, s71, s85
  s_cselect_b32 s16, s72, s86
  s_cselect_b32 s17, s73, s87
  s_cselect_b32 s20, s74, s88
  s_cselect_b32 s21, s75, s89
  s_cselect_b32 s24, s64, s78
  s_cselect_b32 s25, s65, s79
  s_and_b32 s9, s9, 0xffff
  s_mov_b32 s10, 5242880
  s_mov_b32 s11, 0x20000
  s_and_b32 s13, s13, 0xffff
  s_mov_b32 s14, 5242880
  s_mov_b32 s15, 0x20000
  s_and_b32 s17, s17, 0xffff
  s_mov_b32 s18, 5242880
  s_mov_b32 s19, 0x20000
  s_and_b32 s21, s21, 0xffff
  s_mov_b32 s22, 5242880
  s_mov_b32 s23, 0x20000
  s_and_b32 s25, s25, 0xffff
  s_mov_b32 s26, 2621440
  s_mov_b32 s27, 0x20000
  s_mov_b32 s48, s92
  s_mov_b32 s49, s93
  s_mov_b32 s90, s98
  v_lshrrev_b32 v8, 6, v0
  s_nop 0
  v_readfirstlane_b32 s34, v8
  s_mov_b32 s55, 0x40000
  s_mov_b32 s56, 0
  s_nop 2
  s_cmp_ge_u32 s33, 28
  s_cbranch_scc1 Lg3_done
  s_cmp_ge_u32 s33, 14
  s_cselect_b32 s36, 1, 0
  s_mul_i32 s57, s36, 14
  s_sub_u32 s37, s33, s57
  s_mul_i32 s42, s37, 48
  s_lshl_b32 s57, s32, 12
  s_add_u32 s38, s57, 16384
  s_mov_b32 s39, 0
  s_mov_b32 s44, s48
  s_and_b32 s45, s49, 0xffff
  s_mov_b32 s46, 5242880
  s_mov_b32 s47, 0x20000
  v_mov_b32 v5, 0
Linitw_4:
  buffer_load_dword v20, v5, s[28:31], 0 offen offset:64 sc1
  s_waitcnt vmcnt(0)
  v_readfirstlane_b32 s58, v20
  s_nop 3
  s_cmp_ge_u32 s58, 192
  s_cbranch_scc1 Linitw_4_ok
  s_cmp_lg_u32 s56, 0
  s_cbranch_scc1 Linitw_4_ok
  s_sub_u32 s55, s55, 1
  s_cbranch_scc0 Linitw_4
  s_mov_b32 s56, 1
Linitw_4_ok:
  s_lshl_b32 s57, s32, 12
  s_add_u32 s50, s57, 0
Lg3_first:
  buffer_load_dword v20, v5, s[4:7], s50 offen sc1
  s_waitcnt vmcnt(0)
  v_readfirstlane_b32 s58, v20
  s_nop 3
  s_cmp_ge_u32 s58, 1
  s_cbranch_scc1 Lg3_first_ok
  s_cmp_lg_u32 s56, 0
  s_cbranch_scc1 Lg3_first_ok
  s_sleep 8
  s_sub_u32 s55, s55, 1
  s_cbranch_scc0 Lg3_first
  s_mov_b32 s56, 1
Lg3_first_ok:
  v_and_b32 v20, 63, v0
  v_lshlrev_b32 v0, 4, v20
  v_lshrrev_b32 v21, 3, v20
  v_and_b32 v22, 7, v20
  v_mul_u32_u24 v21, 1280, v21
  v_lshl_add_u32 v1, v22, 4, v21
  v_lshrrev_b32 v21, 4, v20
  v_and_b32 v22, 15, v20
  v_lshrrev_b32 v23, 2, v22
  v_lshl_add_u32 v23, v21, 3, v23
  v_lshlrev_b32 v23, 7, v23
  v_and_b32 v24, 3, v22
  v_lshl_add_u32 v23, v24, 3, v23
  s_lshl_b32 s57, s34, 14
  v_add_u32 v2, s57, v23
  s_mul_i32 s58, s34, 1310720
  s_lshl_b32 s57, s42, 1
  s_add_u32 s58, s58, s57
  s_lshl_b32 s62, s34, 14
  s_add_u32 m0, s62, 0
  s_add_u32 s57, s58, 0
  buffer_load_dwordx4 v1, s[20:23], s57 offen nt lds
  s_add_u32 m0, s62, 1024
  s_add_u32 s57, s58, 10240
  buffer_load_dwordx4 v1, s[20:23], s57 offen nt lds
  s_add_u32 m0, s62, 2048
  s_add_u32 s57, s58, 20480
  buffer_load_dwordx4 v1, s[20:23], s57 offen nt lds
  s_add_u32 m0, s62, 3072
  s_add_u32 s57, s58, 30720
  buffer_load_dwordx4 v1, s[20:23], s57 offen nt lds
  s_add_u32 m0, s62, 4096
  s_add_u32 s57, s58, 40960
  buffer_load_dwordx4 v1, s[20:23], s57 offen nt lds
  s_add_u32 m0, s62, 5120
  s_add_u32 s57, s58, 51200
  buffer_load_dwordx4 v1, s[20:23], s57 offen nt lds
  s_add_u32 m0, s62, 6144
  s_add_u32 s57, s58, 61440
  buffer_load_dwordx4 v1, s[20:23], s57 offen nt lds
  s_add_u32 m0, s62, 7168
  s_add_u32 s57, s58, 71680
  buffer_load_dwordx4 v1, s[20:23], s57 offen nt lds
  s_add_u32 m0, s62, 8192
  s_add_u32 s57, s58, 81920
  buffer_load_dwordx4 v1, s[20:23], s57 offen nt lds
  s_add_u32 m0, s62, 9216
  s_add_u32 s57, s58, 92160
  buffer_load_dwordx4 v1, s[20:23], s57 offen nt lds
  s_add_u32 m0, s62, 10240
  s_add_u32 s57, s58, 102400
  buffer_load_dwordx4 v1, s[20:23], s57 offen nt lds
  s_add_u32 m0, s62, 11264
  s_add_u32 s57, s58, 112640
  buffer_load_dwordx4 v1, s[20:23], s57 offen nt lds
  s_add_u32 m0, s62, 12288
  s_add_u32 s57, s58, 122880
  buffer_load_dwordx4 v1, s[20:23], s57 offen nt lds
  s_add_u32 m0, s62, 13312
  s_add_u32 s57, s58, 133120
  buffer_load_dwordx4 v1, s[20:23], s57 offen nt lds
  s_add_u32 m0, s62, 14336
  s_add_u32 s57, s58, 143360
  buffer_load_dwordx4 v1, s[20:23], s57 offen nt lds
  s_add_u32 m0, s62, 15360
  s_add_u32 s57, s58, 153600
  buffer_load_dwordx4 v1, s[20:23], s57 offen nt lds
  s_waitcnt vmcnt(12)
  ds_read_b64_tr_b16 v[128:129], v2 offset:0
  ds_read_b64_tr_b16 v[130:131], v2 offset:512
  ds_read_b64_tr_b16 v[132:133], v2 offset:32
  ds_read_b64_tr_b16 v[134:135], v2 offset:544
  ds_read_b64_tr_b16 v[136:137], v2 offset:64
  ds_read_b64_tr_b16 v[138:139], v2 offset:576
  s_waitcnt lgkmcnt(0)
  s_add_u32 m0, s62, 0
  s_add_u32 s57, s58, 163840
  buffer_load_dwordx4 v1, s[20:23], s57 offen nt lds
  s_add_u32 m0, s62, 1024
  s_add_u32 s57, s58, 174080
  buffer_load_dwordx4 v1, s[20:23], s57 offen nt lds
  s_add_u32 m0, s62, 2048
  s_add_u32 s57, s58, 184320
  buffer_load_dwordx4 v1, s[20:23], s57 offen nt lds
  s_add_u32 m0, s62, 3072
  s_add_u32 s57, s58, 194560
  buffer_load_dwordx4 v1, s[20:23], s57 offen nt lds
  s_waitcnt vmcnt(12)
  ds_read_b64_tr_b16 v[140:141], v2 offset:4096
  ds_read_b64_tr_b16 v[142:143], v2 offset:4608
  ds_read_b64_tr_b16 v[144:145], v2 offset:4128
  ds_read_b64_tr_b16 v[146:147], v2 offset:4640
  ds_read_b64_tr_b16 v[148:149], v2 offset:4160
  ds_read_b64_tr_b16 v[150:151], v2 offset:4672
  s_waitcnt lgkmcnt(0)
  s_add_u32 m0, s62, 4096
  s_add_u32 s57, s58, 204800
  buffer_load_dwordx4 v1, s[20:23], s57 offen nt lds
  s_add_u32 m0, s62, 5120
  s_add_u32 s57, s58, 215040
  buffer_load_dwordx4 v1, s[20:23], s57 offen nt lds
  s_add_u32 m0, s62, 6144
  s_add_u32 s57, s58, 225280
  buffer_load_dwordx4 v1, s[20:23], s57 offen nt lds
  s_add_u32 m0, s62, 7168
  s_add_u32 s57, s58, 235520
  buffer_load_dwordx4 v1, s[20:23], s57 offen nt lds
  s_waitcnt vmcnt(12)
  ds_read_b64_tr_b16 v[152:153], v2 offset:8192
  ds_read_b64_tr_b16 v[154:155], v2 offset:8704
  ds_read_b64_tr_b16 v[156:157], v2 offset:8224
  ds_read_b64_tr_b16 v[158:159], v2 offset:8736
  ds_read_b64_tr_b16 v[160:161], v2 offset:8256
  ds_read_b64_tr_b16 v[162:163], v2 offset:8768
  s_waitcnt lgkmcnt(0)
  s_add_u32 m0, s62, 8192
  s_add_u32 s57, s58, 245760
  buffer_load_dwordx4 v1, s[20:23], s57 offen nt lds
  s_add_u32 m0, s62, 9216
  s_add_u32 s57, s58, 256000
  buffer_load_dwordx4 v1, s[20:23], s57 offen nt lds
  s_add_u32 m0, s62, 10240
  s_add_u32 s57, s58, 266240
  buffer_load_dwordx4 v1, s[20:23], s57 offen nt lds
  s_add_u32 m0, s62, 11264
  s_add_u32 s57, s58, 276480
  buffer_load_dwordx4 v1, s[20:23], s57 offen nt lds
  s_waitcnt vmcnt(12)
  ds_read_b64_tr_b16 v[164:165], v2 offset:12288
  ds_read_b64_tr_b16 v[166:167], v2 offset:12800
  ds_read_b64_tr_b16 v[168:169], v2 offset:12320
  ds_read_b64_tr_b16 v[170:171], v2 offset:12832
  ds_read_b64_tr_b16 v[172:173], v2 offset:12352
  ds_read_b64_tr_b16 v[174:175], v2 offset:12864
  s_waitcnt lgkmcnt(0)
  s_add_u32 m0, s62, 12288
  s_add_u32 s57, s58, 286720
  buffer_load_dwordx4 v1, s[20:23], s57 offen nt lds
  s_add_u32 m0, s62, 13312
  s_add_u32 s57, s58, 296960
  buffer_load_dwordx4 v1, s[20:23], s57 offen nt lds
  s_add_u32 m0, s62, 14336
  s_add_u32 s57, s58, 307200
  buffer_load_dwordx4 v1, s[20:23], s57 offen nt lds
  s_add_u32 m0, s62, 15360
  s_add_u32 s57, s58, 317440
  buffer_load_dwordx4 v1, s[20:23], s57 offen nt lds
  s_waitcnt vmcnt(12)
  ds_read_b64_tr_b16 v[176:177], v2 offset:0
  ds_read_b64_tr_b16 v[178:179], v2 offset:512
  ds_read_b64_tr_b16 v[180:181], v2 offset:32
  ds_read_b64_tr_b16 v[182:183], v2 offset:544
  ds_read_b64_tr_b16 v[184:185], v2 offset:64
  ds_read_b64_tr_b16 v[186:187], v2 offset:576
  s_waitcnt lgkmcnt(0)
  s_add_u32 m0, s62, 0
  s_add_u32 s57, s58, 327680
  buffer_load_dwordx4 v1, s[20:23], s57 offen nt lds
  s_add_u32 m0, s62, 1024
  s_add_u32 s57, s58, 337920
  buffer_load_dwordx4 v1, s[20:23], s57 offen nt lds
  s_add_u32 m0, s62, 2048
  s_add_u32 s57, s58, 348160
  buffer_load_dwordx4 v1, s[20:23], s57 offen nt lds
  s_add_u32 m0, s62, 3072
  s_add_u32 s57, s58, 358400
  buffer_load_dwordx4 v1, s[20:23], s57 offen nt lds
  s_waitcnt vmcnt(12)
  ds_read_b64_tr_b16 v[188:189], v2 offset:4096
  ds_read_b64_tr_b16 v[190:191], v2 offset:4608
  ds_read_b64_tr_b16 v[192:193], v2 offset:4128
  ds_read_b64_tr_b16 v[194:195], v2 offset:4640
  ds_read_b64_tr_b16 v[196:197], v2 offset:4160
  ds_read_b64_tr_b16 v[198:199], v2 offset:4672
  s_waitcnt lgkmcnt(0)
  s_add_u32 m0, s62, 4096
  s_add_u32 s57, s58, 368640
  buffer_load_dwordx4 v1, s[20:23], s57 offen nt lds
  s_add_u32 m0, s62, 5120
  s_add_u32 s57, s58, 378880
  buffer_load_dwordx4 v1, s[20:23], s57 offen nt lds
  s_add_u32 m0, s62, 6144
  s_add_u32 s57, s58, 389120
  buffer_load_dwordx4 v1, s[20:23], s57 offen nt lds
  s_add_u32 m0, s62, 7168
  s_add_u32 s57, s58, 399360
  buffer_load_dwordx4 v1, s[20:23], s57 offen nt lds
  s_waitcnt vmcnt(12)
  ds_read_b64_tr_b16 v[200:201], v2 offset:8192
  ds_read_b64_tr_b16 v[202:203], v2 offset:8704
  ds_read_b64_tr_b16 v[204:205], v2 offset:8224
  ds_read_b64_tr_b16 v[206:207], v2 offset:8736
  ds_read_b64_tr_b16 v[208:209], v2 offset:8256
  ds_read_b64_tr_b16 v[210:211], v2 offset:8768
  s_waitcnt lgkmcnt(0)
  s_add_u32 m0, s62, 8192
  s_add_u32 s57, s58, 409600
  buffer_load_dwordx4 v1, s[20:23], s57 offen nt lds
  s_add_u32 m0, s62, 9216
  s_add_u32 s57, s58, 419840
  buffer_load_dwordx4 v1, s[20:23], s57 offen nt lds
  s_add_u32 m0, s62, 10240
  s_add_u32 s57, s58, 430080
  buffer_load_dwordx4 v1, s[20:23], s57 offen nt lds
  s_add_u32 m0, s62, 11264
  s_add_u32 s57, s58, 440320
  buffer_load_dwordx4 v1, s[20:23], s57 offen nt lds
  s_waitcnt vmcnt(12)
  ds_read_b64_tr_b16 v[212:213], v2 offset:12288
  ds_read_b64_tr_b16 v[214:215], v2 offset:12800
  ds_read_b64_tr_b16 v[216:217], v2 offset:12320
  ds_read_b64_tr_b16 v[218:219], v2 offset:12832
  ds_read_b64_tr_b16 v[220:221], v2 offset:12352
  ds_read_b64_tr_b16 v[222:223], v2 offset:12864
  s_waitcnt lgkmcnt(0)
  s_add_u32 m0, s62, 12288
  s_add_u32 s57, s58, 450560
  buffer_load_dwordx4 v1, s[20:23], s57 offen nt lds
  s_add_u32 m0, s62, 13312
  s_add_u32 s57, s58, 460800
  buffer_load_dwordx4 v1, s[20:23], s57 offen nt lds
  s_add_u32 m0, s62, 14336
  s_add_u32 s57, s58, 471040
  buffer_load_dwordx4 v1, s[20:23], s57 offen nt lds
  s_add_u32 m0, s62, 15360
  s_add_u32 s57, s58, 481280
  buffer_load_dwordx4 v1, s[20:23], s57 offen nt lds
  s_waitcnt vmcnt(12)
  ds_read_b64_tr_b16 v[224:225], v2 offset:0
  ds_read_b64_tr_b16 v[226:227], v2 offset:512
  ds_read_b64_tr_b16 v[228:229], v2 offset:32
  ds_read_b64_tr_b16 v[230:231], v2 offset:544
  ds_read_b64_tr_b16 v[232:233], v2 offset:64
  ds_read_b64_tr_b16 v[234:235], v2 offset:576
  s_waitcnt lgkmcnt(0)
  s_add_u32 m0, s62, 0
  s_add_u32 s57, s58, 491520
  buffer_load_dwordx4 v1, s[20:23], s57 offen nt lds
  s_add_u32 m0, s62, 1024
  s_add_u32 s57, s58, 501760
  buffer_load_dwordx4 v1, s[20:23], s57 offen nt lds
  s_add_u32 m0, s62, 2048
  s_add_u32 s57, s58, 512000
  buffer_load_dwordx4 v1, s[20:23], s57 offen nt lds
  s_add_u32 m0, s62, 3072
  s_add_u32 s57, s58, 522240
  buffer_load_dwordx4 v1, s[20:23], s57 offen nt lds
  s_waitcnt vmcnt(12)
  ds_read_b64_tr_b16 v[236:237], v2 offset:4096
  ds_read_b64_tr_b16 v[238:239], v2 offset:4608
  ds_read_b64_tr_b16 v[240:241], v2 offset:4128
  ds_read_b64_tr_b16 v[242:243], v2 offset:4640
  ds_read_b64_tr_b16 v[244:245], v2 offset:4160
  ds_read_b64_tr_b16 v[246:247], v2 offset:4672
  s_waitcnt lgkmcnt(0)
  s_add_u32 m0, s62, 4096
  s_add_u32 s57, s58, 532480
  buffer_load_dwordx4 v1, s[20:23], s57 offen nt lds
  s_add_u32 m0, s62, 5120
  s_add_u32 s57, s58, 542720
  buffer_load_dwordx4 v1, s[20:23], s57 offen nt lds
  s_add_u32 m0, s62, 6144
  s_add_u32 s57, s58, 552960
  buffer_load_dwordx4 v1, s[20:23], s57 offen nt lds
  s_add_u32 m0, s62, 7168
  s_add_u32 s57, s58, 563200
  buffer_load_dwordx4 v1, s[20:23], s57 offen nt lds
  s_waitcnt vmcnt(12)
  ds_read_b64_tr_b16 v[248:249], v2 offset:8192
  ds_read_b64_tr_b16 v[250:251], v2 offset:8704
  ds_read_b64_tr_b16 v[252:253], v2 offset:8224
  ds_read_b64_tr_b16 v[254:255], v2 offset:8736
  ds_read_b64_tr_b16 a[0:1], v2 offset:8256
  ds_read_b64_tr_b16 a[2:3], v2 offset:8768
  s_waitcnt lgkmcnt(0)
  s_add_u32 m0, s62, 8192
  s_add_u32 s57, s58, 573440
  buffer_load_dwordx4 v1, s[20:23], s57 offen nt lds
  s_add_u32 m0, s62, 9216
  s_add_u32 s57, s58, 583680
  buffer_load_dwordx4 v1, s[20:23], s57 offen nt lds
  s_add_u32 m0, s62, 10240
  s_add_u32 s57, s58, 593920
  buffer_load_dwordx4 v1, s[20:23], s57 offen nt lds
  s_add_u32 m0, s62, 11264
  s_add_u32 s57, s58, 604160
  buffer_load_dwordx4 v1, s[20:23], s57 offen nt lds
  s_waitcnt vmcnt(12)
  ds_read_b64_tr_b16 a[4:5], v2 offset:12288
  ds_read_b64_tr_b16 a[6:7], v2 offset:12800
  ds_read_b64_tr_b16 a[8:9], v2 offset:12320
  ds_read_b64_tr_b16 a[10:11], v2 offset:12832
  ds_read_b64_tr_b16 a[12:13], v2 offset:12352
  ds_read_b64_tr_b16 a[14:15], v2 offset:12864
  s_waitcnt lgkmcnt(0)
  s_add_u32 m0, s62, 12288
  s_add_u32 s57, s58, 614400
  buffer_load_dwordx4 v1, s[20:23], s57 offen nt lds
  s_add_u32 m0, s62, 13312
  s_add_u32 s57, s58, 624640
  buffer_load_dwordx4 v1, s[20:23], s57 offen nt lds
  s_add_u32 m0, s62, 14336
  s_add_u32 s57, s58, 634880
  buffer_load_dwordx4 v1, s[20:23], s57 offen nt lds
  s_add_u32 m0, s62, 15360
  s_add_u32 s57, s58, 645120
  buffer_load_dwordx4 v1, s[20:23], s57 offen nt lds
  s_waitcnt vmcnt(12)
  ds_read_b64_tr_b16 a[16:17], v2 offset:0
  ds_read_b64_tr_b16 a[18:19], v2 offset:512
  ds_read_b64_tr_b16 a[20:21], v2 offset:32
  ds_read_b64_tr_b16 a[22:23], v2 offset:544
  ds_read_b64_tr_b16 a[24:25], v2 offset:64
  ds_read_b64_tr_b16 a[26:27], v2 offset:576
  s_waitcnt lgkmcnt(0)
  s_add_u32 m0, s62, 0
  s_add_u32 s57, s58, 655360
  buffer_load_dwordx4 v1, s[20:23], s57 offen nt lds
  s_add_u32 m0, s62, 1024
  s_add_u32 s57, s58, 665600
  buffer_load_dwordx4 v1, s[20:23], s57 offen nt lds
  s_add_u32 m0, s62, 2048
  s_add_u32 s57, s58, 675840
  buffer_load_dwordx4 v1, s[20:23], s57 offen nt lds
  s_add_u32 m0, s62, 3072
  s_add_u32 s57, s58, 686080
  buffer_load_dwordx4 v1, s[20:23], s57 offen nt lds
  s_waitcnt vmcnt(12)
  ds_read_b64_tr_b16 a[28:29], v2 offset:4096
  ds_read_b64_tr_b16 a[30:31], v2 offset:4608
  ds_read_b64_tr_b16 a[32:33], v2 offset:4128
  ds_read_b64_tr_b16 a[34:35], v2 offset:4640
  ds_read_b64_tr_b16 a[36:37], v2 offset:4160
  ds_read_b64_tr_b16 a[38:39], v2 offset:4672
  s_waitcnt lgkmcnt(0)
  s_add_u32 m0, s62, 4096
  s_add_u32 s57, s58, 696320
  buffer_load_dwordx4 v1, s[20:23], s57 offen nt lds
  s_add_u32 m0, s62, 5120
  s_add_u32 s57, s58, 706560
  buffer_load_dwordx4 v1, s[20:23], s57 offen nt lds
  s_add_u32 m0, s62, 6144
  s_add_u32 s57, s58, 716800
  buffer_load_dwordx4 v1, s[20:23], s57 offen nt lds
  s_add_u32 m0, s62, 7168
  s_add_u32 s57, s58, 727040
  buffer_load_dwordx4 v1, s[20:23], s57 offen nt lds
  s_waitcnt vmcnt(12)
  ds_read_b64_tr_b16 a[40:41], v2 offset:8192
  ds_read_b64_tr_b16 a[42:43], v2 offset:8704
  ds_read_b64_tr_b16 a[44:45], v2 offset:8224
  ds_read_b64_tr_b16 a[46:47], v2 offset:8736
  ds_read_b64_tr_b16 a[48:49], v2 offset:8256
  ds_read_b64_tr_b16 a[50:51], v2 offset:8768
  s_waitcnt lgkmcnt(0)
  s_add_u32 m0, s62, 8192
  s_add_u32 s57, s58, 737280
  buffer_load_dwordx4 v1, s[20:23], s57 offen nt lds
  s_add_u32 m0, s62, 9216
  s_add_u32 s57, s58, 747520
  buffer_load_dwordx4 v1, s[20:23], s57 offen nt lds
  s_add_u32 m0, s62, 10240
  s_add_u32 s57, s58, 757760
  buffer_load_dwordx4 v1, s[20:23], s57 offen nt lds
  s_add_u32 m0, s62, 11264
  s_add_u32 s57, s58, 768000
  buffer_load_dwordx4 v1, s[20:23], s57 offen nt lds
  s_waitcnt vmcnt(12)
  ds_read_b64_tr_b16 a[52:53], v2 offset:12288
  ds_read_b64_tr_b16 a[54:55], v2 offset:12800
  ds_read_b64_tr_b16 a[56:57], v2 offset:12320
  ds_read_b64_tr_b16 a[58:59], v2 offset:12832
  ds_read_b64_tr_b16 a[60:61], v2 offset:12352
  ds_read_b64_tr_b16 a[62:63], v2 offset:12864
  s_waitcnt lgkmcnt(0)
  s_add_u32 m0, s62, 12288
  s_add_u32 s57, s58, 778240
  buffer_load_dwordx4 v1, s[20:23], s57 offen nt lds
  s_add_u32 m0, s62, 13312
  s_add_u32 s57, s58, 788480
  buffer_load_dwordx4 v1, s[20:23], s57 offen nt lds
  s_add_u32 m0, s62, 14336
  s_add_u32 s57, s58, 798720
  buffer_load_dwordx4 v1, s[20:23], s57 offen nt lds
  s_add_u32 m0, s62, 15360
  s_add_u32 s57, s58, 808960
  buffer_load_dwordx4 v1, s[20:23], s57 offen nt lds
  s_waitcnt vmcnt(12)
  ds_read_b64_tr_b16 a[64:65], v2 offset:0
  ds_read_b64_tr_b16 a[66:67], v2 offset:512
  ds_read_b64_tr_b16 a[68:69], v2 offset:32
  ds_read_b64_tr_b16 a[70:71], v2 offset:544
  ds_read_b64_tr_b16 a[72:73], v2 offset:64
  ds_read_b64_tr_b16 a[74:75], v2 offset:576
  s_waitcnt lgkmcnt(0)
  s_add_u32 m0, s62, 0
  s_add_u32 s57, s58, 819200
  buffer_load_dwordx4 v1, s[20:23], s57 offen nt lds
  s_add_u32 m0, s62, 1024
  s_add_u32 s57, s58, 829440
  buffer_load_dwordx4 v1, s[20:23], s57 offen nt lds
  s_add_u32 m0, s62, 2048
  s_add_u32 s57, s58, 839680
  buffer_load_dwordx4 v1, s[20:23], s57 offen nt lds
  s_add_u32 m0, s62, 3072
  s_add_u32 s57, s58, 849920
  buffer_load_dwordx4 v1, s[20:23], s57 offen nt lds
  s_waitcnt vmcnt(12)
  ds_read_b64_tr_b16 a[76:77], v2 offset:4096
  ds_read_b64_tr_b16 a[78:79], v2 offset:4608
  ds_read_b64_tr_b16 a[80:81], v2 offset:4128
  ds_read_b64_tr_b16 a[82:83], v2 offset:4640
  ds_read_b64_tr_b16 a[84:85], v2 offset:4160
  ds_read_b64_tr_b16 a[86:87], v2 offset:4672
  s_waitcnt lgkmcnt(0)
  s_add_u32 m0, s62, 4096
  s_add_u32 s57, s58, 860160
  buffer_load_dwordx4 v1, s[20:23], s57 offen nt lds
  s_add_u32 m0, s62, 5120
  s_add_u32 s57, s58, 870400
  buffer_load_dwordx4 v1, s[20:23], s57 offen nt lds
  s_add_u32 m0, s62, 6144
  s_add_u32 s57, s58, 880640
  buffer_load_dwordx4 v1, s[20:23], s57 offen nt lds
  s_add_u32 m0, s62, 7168
  s_add_u32 s57, s58, 890880
  buffer_load_dwordx4 v1, s[20:23], s57 offen nt lds
  s_waitcnt vmcnt(12)
  ds_read_b64_tr_b16 a[88:89], v2 offset:8192
  ds_read_b64_tr_b16 a[90:91], v2 offset:8704
  ds_read_b64_tr_b16 a[92:93], v2 offset:8224
  ds_read_b64_tr_b16 a[94:95], v2 offset:8736
  ds_read_b64_tr_b16 a[96:97], v2 offset:8256
  ds_read_b64_tr_b16 a[98:99], v2 offset:8768
  s_waitcnt lgkmcnt(0)
  s_add_u32 m0, s62, 8192
  s_add_u32 s57, s58, 901120
  buffer_load_dwordx4 v1, s[20:23], s57 offen nt lds
  s_add_u32 m0, s62, 9216
  s_add_u32 s57, s58, 911360
  buffer_load_dwordx4 v1, s[20:23], s57 offen nt lds
  s_add_u32 m0, s62, 10240
  s_add_u32 s57, s58, 921600
  buffer_load_dwordx4 v1, s[20:23], s57 offen nt lds
  s_add_u32 m0, s62, 11264
  s_add_u32 s57, s58, 931840
  buffer_load_dwordx4 v1, s[20:23], s57 offen nt lds
  s_waitcnt vmcnt(12)
  ds_read_b64_tr_b16 a[100:101], v2 offset:12288
  ds_read_b64_tr_b16 a[102:103], v2 offset:12800
  ds_read_b64_tr_b16 a[104:105], v2 offset:12320
  ds_read_b64_tr_b16 a[106:107], v2 offset:12832
  ds_read_b64_tr_b16 a[108:109], v2 offset:12352
  ds_read_b64_tr_b16 a[110:111], v2 offset:12864
  s_waitcnt lgkmcnt(0)
  s_add_u32 m0, s62, 12288
  s_add_u32 s57, s58, 942080
  buffer_load_dwordx4 v1, s[20:23], s57 offen nt lds
  s_add_u32 m0, s62, 13312
  s_add_u32 s57, s58, 952320
  buffer_load_dwordx4 v1, s[20:23], s57 offen nt lds
  s_add_u32 m0, s62, 14336
  s_add_u32 s57, s58, 962560
  buffer_load_dwordx4 v1, s[20:23], s57 offen nt lds
  s_add_u32 m0, s62, 15360
  s_add_u32 s57, s58, 972800
  buffer_load_dwordx4 v1, s[20:23], s57 offen nt lds
  s_waitcnt vmcnt(12)
  ds_read_b64_tr_b16 a[112:113], v2 offset:0
  ds_read_b64_tr_b16 a[114:115], v2 offset:512
  ds_read_b64_tr_b16 a[116:117], v2 offset:32
  ds_read_b64_tr_b16 a[118:119], v2 offset:544
  ds_read_b64_tr_b16 a[120:121], v2 offset:64
  ds_read_b64_tr_b16 a[122:123], v2 offset:576
  s_waitcnt lgkmcnt(0)
  s_add_u32 m0, s62, 0
  s_add_u32 s57, s58, 983040
  buffer_load_dwordx4 v1, s[20:23], s57 offen nt lds
  s_add_u32 m0, s62, 1024
  s_add_u32 s57, s58, 993280
  buffer_load_dwordx4 v1, s[20:23], s57 offen nt lds
  s_add_u32 m0, s62, 2048
  s_add_u32 s57, s58, 1003520
  buffer_load_dwordx4 v1, s[20:23], s57 offen nt lds
  s_add_u32 m0, s62, 3072
  s_add_u32 s57, s58, 1013760
  buffer_load_dwordx4 v1, s[20:23], s57 offen nt lds
  s_waitcnt vmcnt(12)
  ds_read_b64_tr_b16 a[124:125], v2 offset:4096
  ds_read_b64_tr_b16 a[126:127], v2 offset:4608
  ds_read_b64_tr_b16 a[128:129], v2 offset:4128
  ds_read_b64_tr_b16 a[130:131], v2 offset:4640
  ds_read_b64_tr_b16 a[132:133], v2 offset:4160
  ds_read_b64_tr_b16 a[134:135], v2 offset:4672
  s_waitcnt lgkmcnt(0)
  s_add_u32 m0, s62, 4096
  s_add_u32 s57, s58, 1024000
  buffer_load_dwordx4 v1, s[20:23], s57 offen nt lds
  s_add_u32 m0, s62, 5120
  s_add_u32 s57, s58, 1034240
  buffer_load_dwordx4 v1, s[20:23], s57 offen nt lds
  s_add_u32 m0, s62, 6144
  s_add_u32 s57, s58, 1044480
  buffer_load_dwordx4 v1, s[20:23], s57 offen nt lds
  s_add_u32 m0, s62, 7168
  s_add_u32 s57, s58, 1054720
  buffer_load_dwordx4 v1, s[20:23], s57 offen nt lds
  s_waitcnt vmcnt(12)
  ds_read_b64_tr_b16 a[136:137], v2 offset:8192
  ds_read_b64_tr_b16 a[138:139], v2 offset:8704
  ds_read_b64_tr_b16 a[140:141], v2 offset:8224
  ds_read_b64_tr_b16 a[142:143], v2 offset:8736
  ds_read_b64_tr_b16 a[144:145], v2 offset:8256
  ds_read_b64_tr_b16 a[146:147], v2 offset:8768
  s_waitcnt lgkmcnt(0)
  s_add_u32 m0, s62, 8192
  s_add_u32 s57, s58, 1064960
  buffer_load_dwordx4 v1, s[20:23], s57 offen nt lds
  s_add_u32 m0, s62, 9216
  s_add_u32 s57, s58, 1075200
  buffer_load_dwordx4 v1, s[20:23], s57 offen nt lds
  s_add_u32 m0, s62, 10240
  s_add_u32 s57, s58, 1085440
  buffer_load_dwordx4 v1, s[20:23], s57 offen nt lds
  s_add_u32 m0, s62, 11264
  s_add_u32 s57, s58, 1095680
  buffer_load_dwordx4 v1, s[20:23], s57 offen nt lds
  s_waitcnt vmcnt(12)
  ds_read_b64_tr_b16 a[148:149], v2 offset:12288
  ds_read_b64_tr_b16 a[150:151], v2 offset:12800
  ds_read_b64_tr_b16 a[152:153], v2 offset:12320
  ds_read_b64_tr_b16 a[154:155], v2 offset:12832
  ds_read_b64_tr_b16 a[156:157], v2 offset:12352
  ds_read_b64_tr_b16 a[158:159], v2 offset:12864
  s_waitcnt lgkmcnt(0)
  s_add_u32 m0, s62, 12288
  s_add_u32 s57, s58, 1105920
  buffer_load_dwordx4 v1, s[20:23], s57 offen nt lds
  s_add_u32 m0, s62, 13312
  s_add_u32 s57, s58, 1116160
  buffer_load_dwordx4 v1, s[20:23], s57 offen nt lds
  s_add_u32 m0, s62, 14336
  s_add_u32 s57, s58, 1126400
  buffer_load_dwordx4 v1, s[20:23], s57 offen nt lds
  s_add_u32 m0, s62, 15360
  s_add_u32 s57, s58, 1136640
  buffer_load_dwordx4 v1, s[20:23], s57 offen nt lds
  s_waitcnt vmcnt(12)
  ds_read_b64_tr_b16 a[160:161], v2 offset:0
  ds_read_b64_tr_b16 a[162:163], v2 offset:512
  ds_read_b64_tr_b16 a[164:165], v2 offset:32
  ds_read_b64_tr_b16 a[166:167], v2 offset:544
  ds_read_b64_tr_b16 a[168:169], v2 offset:64
  ds_read_b64_tr_b16 a[170:171], v2 offset:576
  s_waitcnt lgkmcnt(0)
  s_add_u32 m0, s62, 0
  s_add_u32 s57, s58, 1146880
  buffer_load_dwordx4 v1, s[20:23], s57 offen nt lds
  s_add_u32 m0, s62, 1024
  s_add_u32 s57, s58, 1157120
  buffer_load_dwordx4 v1, s[20:23], s57 offen nt lds
  s_add_u32 m0, s62, 2048
  s_add_u32 s57, s58, 1167360
  buffer_load_dwordx4 v1, s[20:23], s57 offen nt lds
  s_add_u32 m0, s62, 3072
  s_add_u32 s57, s58, 1177600
  buffer_load_dwordx4 v1, s[20:23], s57 offen nt lds
  s_waitcnt vmcnt(12)
  ds_read_b64_tr_b16 a[172:173], v2 offset:4096
  ds_read_b64_tr_b16 a[174:175], v2 offset:4608
  ds_read_b64_tr_b16 a[176:177], v2 offset:4128
  ds_read_b64_tr_b16 a[178:179], v2 offset:4640
  ds_read_b64_tr_b16 a[180:181], v2 offset:4160
  ds_read_b64_tr_b16 a[182:183], v2 offset:4672
  s_waitcnt lgkmcnt(0)
  s_add_u32 m0, s62, 4096
  s_add_u32 s57, s58, 1187840
  buffer_load_dwordx4 v1, s[20:23], s57 offen nt lds
  s_add_u32 m0, s62, 5120
  s_add_u32 s57, s58, 1198080
  buffer_load_dwordx4 v1, s[20:23], s57 offen nt lds
  s_add_u32 m0, s62, 6144
  s_add_u32 s57, s58, 1208320
  buffer_load_dwordx4 v1, s[20:23], s57 offen nt lds
  s_add_u32 m0, s62, 7168
  s_add_u32 s57, s58, 1218560
  buffer_load_dwordx4 v1, s[20:23], s57 offen nt lds
  s_waitcnt vmcnt(12)
  ds_read_b64_tr_b16 a[184:185], v2 offset:8192
  ds_read_b64_tr_b16 a[186:187], v2 offset:8704
  ds_read_b64_tr_b16 a[188:189], v2 offset:8224
  ds_read_b64_tr_b16 a[190:191], v2 offset:8736
  ds_read_b64_tr_b16 a[192:193], v2 offset:8256
  ds_read_b64_tr_b16 a[194:195], v2 offset:8768
  s_waitcnt lgkmcnt(0)
  s_add_u32 m0, s62, 8192
  s_add_u32 s57, s58, 1228800
  buffer_load_dwordx4 v1, s[20:23], s57 offen nt lds
  s_add_u32 m0, s62, 9216
  s_add_u32 s57, s58, 1239040
  buffer_load_dwordx4 v1, s[20:23], s57 offen nt lds
  s_add_u32 m0, s62, 10240
  s_add_u32 s57, s58, 1249280
  buffer_load_dwordx4 v1, s[20:23], s57 offen nt lds
  s_add_u32 m0, s62, 11264
  s_add_u32 s57, s58, 1259520
  buffer_load_dwordx4 v1, s[20:23], s57 offen nt lds
  s_waitcnt vmcnt(12)
  ds_read_b64_tr_b16 a[196:197], v2 offset:12288
  ds_read_b64_tr_b16 a[198:199], v2 offset:12800
  ds_read_b64_tr_b16 a[200:201], v2 offset:12320
  ds_read_b64_tr_b16 a[202:203], v2 offset:12832
  ds_read_b64_tr_b16 a[204:205], v2 offset:12352
  ds_read_b64_tr_b16 a[206:207], v2 offset:12864
  s_waitcnt lgkmcnt(0)
  s_add_u32 m0, s62, 12288
  s_add_u32 s57, s58, 1269760
  buffer_load_dwordx4 v1, s[20:23], s57 offen nt lds
  s_add_u32 m0, s62, 13312
  s_add_u32 s57, s58, 1280000
  buffer_load_dwordx4 v1, s[20:23], s57 offen nt lds
  s_add_u32 m0, s62, 14336
  s_add_u32 s57, s58, 1290240
  buffer_load_dwordx4 v1, s[20:23], s57 offen nt lds
  s_add_u32 m0, s62, 15360
  s_add_u32 s57, s58, 1300480
  buffer_load_dwordx4 v1, s[20:23], s57 offen nt lds
  s_waitcnt vmcnt(12)
  ds_read_b64_tr_b16 a[208:209], v2 offset:0
  ds_read_b64_tr_b16 a[210:211], v2 offset:512
  ds_read_b64_tr_b16 a[212:213], v2 offset:32
  ds_read_b64_tr_b16 a[214:215], v2 offset:544
  ds_read_b64_tr_b16 a[216:217], v2 offset:64
  ds_read_b64_tr_b16 a[218:219], v2 offset:576
  s_waitcnt lgkmcnt(0)
  s_waitcnt vmcnt(8)
  ds_read_b64_tr_b16 a[220:221], v2 offset:4096
  ds_read_b64_tr_b16 a[222:223], v2 offset:4608
  ds_read_b64_tr_b16 a[224:225], v2 offset:4128
  ds_read_b64_tr_b16 a[226:227], v2 offset:4640
  ds_read_b64_tr_b16 a[228:229], v2 offset:4160
  ds_read_b64_tr_b16 a[230:231], v2 offset:4672
  s_waitcnt lgkmcnt(0)
  s_waitcnt vmcnt(4)
  ds_read_b64_tr_b16 a[232:233], v2 offset:8192
  ds_read_b64_tr_b16 a[234:235], v2 offset:8704
  ds_read_b64_tr_b16 a[236:237], v2 offset:8224
  ds_read_b64_tr_b16 a[238:239], v2 offset:8736
  ds_read_b64_tr_b16 a[240:241], v2 offset:8256
  ds_read_b64_tr_b16 a[242:243], v2 offset:8768
  s_waitcnt lgkmcnt(0)
  s_waitcnt vmcnt(0)
  ds_read_b64_tr_b16 a[244:245], v2 offset:12288
  ds_read_b64_tr_b16 a[246:247], v2 offset:12800
  ds_read_b64_tr_b16 a[248:249], v2 offset:12320
  ds_read_b64_tr_b16 a[250:251], v2 offset:12832
  ds_read_b64_tr_b16 a[252:253], v2 offset:12352
  ds_read_b64_tr_b16 a[254:255], v2 offset:12864
  s_waitcnt lgkmcnt(0)
  v_lshrrev_b32 v20, 4, v0
  v_and_b32 v21, 31, v20
  v_lshlrev_b32 v3, 7, v21
  v_and_b32 v21, 15, v20
  v_lshrrev_b32 v22, 4, v20
  v_mul_u32_u24 v21, 2560, v21
  v_lshl_add_u32 v4, v22, 3, v21
  v_mov_b32 v5, 0
  s_lshl_b32 s40, s32, 24
  s_add_u32 s40, s40, 100663296
  s_lshl_b32 s57, s36, 17
  s_add_u32 s40, s40, s57
  s_lshl_b32 s57, s34, 15
  s_add_u32 s40, s40, s57
  s_mul_i32 s41, s36, 40960
  s_mul_i32 s57, s32, 1280
  s_add_u32 s41, s41, s57
  s_lshl_b32 s57, s42, 1
  s_add_u32 s41, s41, s57
  s_lshl_b32 s57, s34, 5
  s_add_u32 s41, s41, s57
  s_lshl_b32 s57, s34, 4
  s_add_u32 s57, s57, s42
  s_cmp_lt_u32 s57, 640
  s_cselect_b32 s58, 0, 0x40000000
  s_add_u32 s41, s41, s58
  s_mov_b32 s35, 0
  s_mul_i32 s57, s34, 3072
  v_add_u32 v6, s57, v0
  s_lshl_b32 s57, s34, 10
  v_add_u32 v7, s57, v0
Lg3_seg:
  s_add_u32 s59, s35, 1
  s_cmp_ge_u32 s39, s59
  s_cbranch_scc1 Lg3_ok
Lg3_poll:
  buffer_load_dword v20, v3, s[4:7], s38 offen sc1
  s_waitcnt vmcnt(0)
  v_min_u32_dpp v20, v20, v20 row_ror:1 row_mask:0xf bank_mask:0xf
  s_nop 1
  v_min_u32_dpp v20, v20, v20 row_ror:2 row_mask:0xf bank_mask:0xf
  s_nop 1
  v_min_u32_dpp v20, v20, v20 row_ror:4 row_mask:0xf bank_mask:0xf
  s_nop 1
  v_min_u32_dpp v20, v20, v20 row_ror:8 row_mask:0xf bank_mask:0xf
  s_nop 1
  v_readlane_b32 s57, v20, 0
  v_readlane_b32 s58, v20, 16
  s_nop 3
  s_min_u32 s39, s57, s58
  s_cmp_ge_u32 s39, s59
  s_cbranch_scc1 Lg3_ok
  s_cmp_lg_u32 s56, 0
  s_cbranch_scc1 Lg3_ok
  s_sub_u32 s55, s55, 1
  s_cbranch_scc0 Lg3_poll
  s_mov_b32 s56, 1
Lg3_ok:
  s_add_u32 s57, s40, 0
  buffer_load_dwordx4 v[32:35], v0, s[4:7], s57 offen sc1
  s_add_u32 s57, s40, 1024
  buffer_load_dwordx4 v[36:39], v0, s[4:7], s57 offen sc1
  s_add_u32 s57, s40, 2048
  buffer_load_dwordx4 v[40:43], v0, s[4:7], s57 offen sc1
  s_add_u32 s57, s40, 3072
  buffer_load_dwordx4 v[44:47], v0, s[4:7], s57 offen sc1
  s_add_u32 s57, s40, 4096
  buffer_load_dwordx4 v[48:51], v0, s[4:7], s57 offen sc1
  s_add_u32 s57, s40, 5120
  buffer_load_dwordx4 v[52:55], v0, s[4:7], s57 offen sc1
  s_add_u32 s57, s40, 6144
  buffer_load_dwordx4 v[56:59], v0, s[4:7], s57 offen sc1
  s_add_u32 s57, s40, 7168
  buffer_load_dwordx4 v[60:63], v0, s[4:7], s57 offen sc1
  s_add_u32 s57, s40, 8192
  buffer_load_dwordx4 v[64:67], v0, s[4:7], s57 offen sc1
  s_add_u32 s57, s40, 9216
  buffer_load_dwordx4 v[68:71], v0, s[4:7], s57 offen sc1
  s_add_u32 s57, s40, 10240
  buffer_load_dwordx4 v[72:75], v0, s[4:7], s57 offen sc1
  s_add_u32 s57, s40, 11264
  buffer_load_dwordx4 v[76:79], v0, s[4:7], s57 offen sc1
  s_add_u32 s57, s40, 12288
  buffer_load_dwordx4 v[80:83], v0, s[4:7], s57 offen sc1
  s_add_u32 s57, s40, 13312
  buffer_load_dwordx4 v[84:87], v0, s[4:7], s57 offen sc1
  s_add_u32 s57, s40, 14336
  buffer_load_dwordx4 v[88:91], v0, s[4:7], s57 offen sc1
  s_add_u32 s57, s40, 15360
  buffer_load_dwordx4 v[92:95], v0, s[4:7], s57 offen sc1
  s_add_u32 s57, s40, 16384
  buffer_load_dwordx4 v[96:99], v0, s[4:7], s57 offen sc1
  s_add_u32 s57, s40, 17408
  buffer_load_dwordx4 v[100:103], v0, s[4:7], s57 offen sc1
  s_add_u32 s57, s40, 18432
  buffer_load_dwordx4 v[104:107], v0, s[4:7], s57 offen sc1
  s_add_u32 s57, s40, 19456
  buffer_load_dwordx4 v[108:111], v0, s[4:7], s57 offen sc1
  s_add_u32 s57, s40, 20480
  buffer_load_dwordx4 v[112:115], v0, s[4:7], s57 offen sc1
  s_add_u32 s57, s40, 21504
  buffer_load_dwordx4 v[116:119], v0, s[4:7], s57 offen sc1
  s_add_u32 s57, s40, 22528
  buffer_load_dwordx4 v[120:123], v0, s[4:7], s57 offen sc1
  s_add_u32 s57, s40, 23552
  buffer_load_dwordx4 v[124:127], v0, s[4:7], s57 offen sc1
  s_waitcnt vmcnt(23)
  v_mfma_f32_16x16x32_bf16 v[8:11], v[128:131], v[32:35], 0
  v_mfma_f32_16x16x32_bf16 v[12:15], v[132:135], v[32:35], 0
  v_mfma_f32_16x16x32_bf16 v[16:19], v[136:139], v[32:35], 0
  s_add_u32 s57, s40, 24576
  buffer_load_dwordx4 v[32:35], v0, s[4:7], s57 offen sc1
  s_waitcnt vmcnt(23)
  v_mfma_f32_16x16x32_bf16 v[8:11], v[140:143], v[36:39], v[8:11]
  v_mfma_f32_16x16x32_bf16 v[12:15], v[144:147], v[36:39], v[12:15]
  v_mfma_f32_16x16x32_bf16 v[16:19], v[148:151], v[36:39], v[16:19]
  s_add_u32 s57, s40, 25600
  buffer_load_dwordx4 v[36:39], v0, s[4:7], s57 offen sc1
  s_waitcnt vmcnt(23)
  v_mfma_f32_16x16x32_bf16 v[8:11], v[152:155], v[40:43], v[8:11]
  v_mfma_f32_16x16x32_bf16 v[12:15], v[156:159], v[40:43], v[12:15]
  v_mfma_f32_16x16x32_bf16 v[16:19], v[160:163], v[40:43], v[16:19]
  s_add_u32 s57, s40, 26624
  buffer_load_dwordx4 v[40:43], v0, s[4:7], s57 offen sc1
  s_waitcnt vmcnt(23)
  v_mfma_f32_16x16x32_bf16 v[8:11], v[164:167], v[44:47], v[8:11]
  v_mfma_f32_16x16x32_bf16 v[12:15], v[168:171], v[44:47], v[12:15]
  v_mfma_f32_16x16x32_bf16 v[16:19], v[172:175], v[44:47], v[16:19]
  s_add_u32 s57, s40, 27648
  buffer_load_dwordx4 v[44:47], v0, s[4:7], s57 offen sc1
  s_waitcnt vmcnt(23)
  v_mfma_f32_16x16x32_bf16 v[8:11], v[176:179], v[48:51], v[8:11]
  v_mfma_f32_16x16x32_bf16 v[12:15], v[180:183], v[48:51], v[12:15]
  v_mfma_f32_16x16x32_bf16 v[16:19], v[184:187], v[48:51], v[16:19]
  s_add_u32 s57, s40, 28672
  buffer_load_dwordx4 v[48:51], v0, s[4:7], s57 offen sc1
  s_waitcnt vmcnt(23)
  v_mfma_f32_16x16x32_bf16 v[8:11], v[188:191], v[52:55], v[8:11]
  v_mfma_f32_16x16x32_bf16 v[12:15], v[192:195], v[52:55], v[12:15]
  v_mfma_f32_16x16x32_bf16 v[16:19], v[196:199], v[52:55], v[16:19]
  s_add_u32 s57, s40, 29696
  buffer_load_dwordx4 v[52:55], v0, s[4:7], s57 offen sc1
  s_waitcnt vmcnt(23)
  v_mfma_f32_16x16x32_bf16 v[8:11], v[200:203], v[56:59], v[8:11]
  v_mfma_f32_16x16x32_bf16 v[12:15], v[204:207], v[56:59], v[12:15]
  v_mfma_f32_16x16x32_bf16 v[16:19], v[208:211], v[56:59], v[16:19]
  s_add_u32 s57, s40, 30720
  buffer_load_dwordx4 v[56:59], v0, s[4:7], s57 offen sc1
  s_waitcnt vmcnt(23)
  v_mfma_f32_16x16x32_bf16 v[8:11], v[212:215], v[60:63], v[8:11]
  v_mfma_f32_16x16x32_bf16 v[12:15], v[216:219], v[60:63], v[12:15]
  v_mfma_f32_16x16x32_bf16 v[16:19], v[220:223], v[60:63], v[16:19]
  s_add_u32 s57, s40, 31744
  buffer_load_dwordx4 v[60:63], v0, s[4:7], s57 offen sc1
  s_waitcnt vmcnt(23)
  v_mfma_f32_16x16x32_bf16 v[8:11], v[224:227], v[64:67], v[8:11]
  v_mfma_f32_16x16x32_bf16 v[12:15], v[228:231], v[64:67], v[12:15]
  v_mfma_f32_16x16x32_bf16 v[16:19], v[232:235], v[64:67], v[16:19]
  s_waitcnt vmcnt(22)
  v_mfma_f32_16x16x32_bf16 v[8:11], v[236:239], v[68:71], v[8:11]
  v_mfma_f32_16x16x32_bf16 v[12:15], v[240:243], v[68:71], v[12:15]
  v_mfma_f32_16x16x32_bf16 v[16:19], v[244:247], v[68:71], v[16:19]
  s_waitcnt vmcnt(21)
  v_mfma_f32_16x16x32_bf16 v[8:11], v[248:251], v[72:75], v[8:11]
  v_mfma_f32_16x16x32_bf16 v[12:15], v[252:255], v[72:75], v[12:15]
  v_mfma_f32_16x16x32_bf16 v[16:19], a[0:3], v[72:75], v[16:19]
  s_waitcnt vmcnt(20)
  v_mfma_f32_16x16x32_bf16 v[8:11], a[4:7], v[76:79], v[8:11]
  v_mfma_f32_16x16x32_bf16 v[12:15], a[8:11], v[76:79], v[12:15]
  v_mfma_f32_16x16x32_bf16 v[16:19], a[12:15], v[76:79], v[16:19]
  s_waitcnt vmcnt(19)
  v_mfma_f32_16x16x32_bf16 v[8:11], a[16:19], v[80:83], v[8:11]
  v_mfma_f32_16x16x32_bf16 v[12:15], a[20:23], v[80:83], v[12:15]
  v_mfma_f32_16x16x32_bf16 v[16:19], a[24:27], v[80:83], v[16:19]
  s_waitcnt vmcnt(18)
  v_mfma_f32_16x16x32_bf16 v[8:11], a[28:31], v[84:87], v[8:11]
  v_mfma_f32_16x16x32_bf16 v[12:15], a[32:35], v[84:87], v[12:15]
  v_mfma_f32_16x16x32_bf16 v[16:19], a[36:39], v[84:87], v[16:19]
  s_waitcnt vmcnt(17)
  v_mfma_f32_16x16x32_bf16 v[8:11], a[40:43], v[88:91], v[8:11]
  v_mfma_f32_16x16x32_bf16 v[12:15], a[44:47], v[88:91], v[12:15]
  v_mfma_f32_16x16x32_bf16 v[16:19], a[48:51], v[88:91], v[16:19]
  s_waitcnt vmcnt(16)
  v_mfma_f32_16x16x32_bf16 v[8:11], a[52:55], v[92:95], v[8:11]
  v_mfma_f32_16x16x32_bf16 v[12:15], a[56:59], v[92:95], v[12:15]
  v_mfma_f32_16x16x32_bf16 v[16:19], a[60:63], v[92:95], v[16:19]
  s_waitcnt vmcnt(15)
  v_mfma_f32_16x16x32_bf16 v[8:11], a[64:67], v[96:99], v[8:11]
  v_mfma_f32_16x16x32_bf16 v[12:15], a[68:71], v[96:99], v[12:15]
  v_mfma_f32_16x16x32_bf16 v[16:19], a[72:75], v[96:99], v[16:19]
  s_waitcnt vmcnt(14)
  v_mfma_f32_16x16x32_bf16 v[8:11], a[76:79], v[100:103], v[8:11]
  v_mfma_f32_16x16x32_bf16 v[12:15], a[80:83], v[100:103], v[12:15]
  v_mfma_f32_16x16x32_bf16 v[16:19], a[84:87], v[100:103], v[16:19]
  s_waitcnt vmcnt(13)
  v_mfma_f32_16x16x32_bf16 v[8:11], a[88:91], v[104:107], v[8:11]
  v_mfma_f32_16x16x32_bf16 v[12:15], a[92:95], v[104:107], v[12:15]
  v_mfma_f32_16x16x32_bf16 v[16:19], a[96:99], v[104:107], v[16:19]
  s_waitcnt vmcnt(12)
  v_mfma_f32_16x16x32_bf16 v[8:11], a[100:103], v[108:111], v[8:11]
  v_mfma_f32_16x16x32_bf16 v[12:15], a[104:107], v[108:111], v[12:15]
  v_mfma_f32_16x16x32_bf16 v[16:19], a[108:111], v[108:111], v[16:19]
  s_waitcnt vmcnt(11)
  v_mfma_f32_16x16x32_bf16 v[8:11], a[112:115], v[112:115], v[8:11]
  v_mfma_f32_16x16x32_bf16 v[12:15], a[116:119], v[112:115], v[12:15]
  v_mfma_f32_16x16x32_bf16 v[16:19], a[120:123], v[112:115], v[16:19]
  s_waitcnt vmcnt(10)
  v_mfma_f32_16x16x32_bf16 v[8:11], a[124:127], v[116:119], v[8:11]
  v_mfma_f32_16x16x32_bf16 v[12:15], a[128:131], v[116:119], v[12:15]
  v_mfma_f32_16x16x32_bf16 v[16:19], a[132:135], v[116:119], v[16:19]
  s_waitcnt vmcnt(9)
  v_mfma_f32_16x16x32_bf16 v[8:11], a[136:139], v[120:123], v[8:11]
  v_mfma_f32_16x16x32_bf16 v[12:15], a[140:143], v[120:123], v[12:15]
  v_mfma_f32_16x16x32_bf16 v[16:19], a[144:147], v[120:123], v[16:19]
  s_waitcnt vmcnt(8)
  v_mfma_f32_16x16x32_bf16 v[8:11], a[148:151], v[124:127], v[8:11]
  v_mfma_f32_16x16x32_bf16 v[12:15], a[152:155], v[124:127], v[12:15]
  v_mfma_f32_16x16x32_bf16 v[16:19], a[156:159], v[124:127], v[16:19]
  s_waitcnt vmcnt(7)
  v_mfma_f32_16x16x32_bf16 v[8:11], a[160:163], v[32:35], v[8:11]
  v_mfma_f32_16x16x32_bf16 v[12:15], a[164:167], v[32:35], v[12:15]
  v_mfma_f32_16x16x32_bf16 v[16:19], a[168:171], v[32:35], v[16:19]
  s_waitcnt vmcnt(6)
  v_mfma_f32_16x16x32_bf16 v[8:11], a[172:175], v[36:39], v[8:11]
  v_mfma_f32_16x16x32_bf16 v[12:15], a[176:179], v[36:39], v[12:15]
  v_mfma_f32_16x16x32_bf16 v[16:19], a[180:183], v[36:39], v[16:19]
  s_waitcnt vmcnt(5)
  v_mfma_f32_16x16x32_bf16 v[8:11], a[184:187], v[40:43], v[8:11]
  v_mfma_f32_16x16x32_bf16 v[12:15], a[188:191], v[40:43], v[12:15]
  v_mfma_f32_16x16x32_bf16 v[16:19], a[192:195], v[40:43], v[16:19]
  s_waitcnt vmcnt(4)
  v_mfma_f32_16x16x32_bf16 v[8:11], a[196:199], v[44:47], v[8:11]
  v_mfma_f32_16x16x32_bf16 v[12:15], a[200:203], v[44:47], v[12:15]
  v_mfma_f32_16x16x32_bf16 v[16:19], a[204:207], v[44:47], v[16:19]
  s_waitcnt vmcnt(3)
  v_mfma_f32_16x16x32_bf16 v[8:11], a[208:211], v[48:51], v[8:11]
  v_mfma_f32_16x16x32_bf16 v[12:15], a[212:215], v[48:51], v[12:15]
  v_mfma_f32_16x16x32_bf16 v[16:19], a[216:219], v[48:51], v[16:19]
  s_waitcnt vmcnt(2)
  v_mfma_f32_16x16x32_bf16 v[8:11], a[220:223], v[52:55], v[8:11]
  v_mfma_f32_16x16x32_bf16 v[12:15], a[224:227], v[52:55], v[12:15]
  v_mfma_f32_16x16x32_bf16 v[16:19], a[228:231], v[52:55], v[16:19]
  s_waitcnt vmcnt(1)
  v_mfma_f32_16x16x32_bf16 v[8:11], a[232:235], v[56:59], v[8:11]
  v_mfma_f32_16x16x32_bf16 v[12:15], a[236:239], v[56:59], v[12:15]
  v_mfma_f32_16x16x32_bf16 v[16:19], a[240:243], v[56:59], v[16:19]
  s_waitcnt vmcnt(0)
  v_mfma_f32_16x16x32_bf16 v[8:11], a[244:247], v[60:63], v[8:11]
  v_mfma_f32_16x16x32_bf16 v[12:15], a[248:251], v[60:63], v[12:15]
  v_mfma_f32_16x16x32_bf16 v[16:19], a[252:255], v[60:63], v[16:19]
  s_and_b32 s57, s35, 1
  s_mul_i32 s57, s57, 12288
  v_add_u32 v20, s57, v6
  v_add_u32 v21, s57, v7
  s_nop 5
  ds_write_b128 v20, v[8:11] offset:0
  ds_write_b128 v20, v[12:15] offset:1024
  ds_write_b128 v20, v[16:19] offset:2048
  s_waitcnt lgkmcnt(0)
  s_barrier
  s_cmp_eq_u32 s34, 3
  s_cbranch_scc1 Lg3_next
  ds_read_b128 v[32:35], v21 offset:0
  ds_read_b128 v[36:39], v21 offset:3072
  ds_read_b128 v[40:43], v21 offset:6144
  ds_read_b128 v[44:47], v21 offset:9216
  s_waitcnt lgkmcnt(0)
  v_add_f32 v32, v32, v36
  v_add_f32 v40, v40, v44
  v_add_f32 v33, v33, v37
  v_add_f32 v41, v41, v45
  v_add_f32 v34, v34, v38
  v_add_f32 v42, v42, v46
  v_add_f32 v35, v35, v39
  v_add_f32 v43, v43, v47
  v_add_f32 v32, v32, v40
  v_add_f32 v33, v33, v41
  v_add_f32 v34, v34, v42
  v_add_f32 v35, v35, v43
  v_cvt_pk_bf16_f32 v32, v32, v33
  v_cvt_pk_bf16_f32 v33, v34, v35
  buffer_store_dwordx2 v[32:33], v4, s[44:47], s41 offen
Lg3_next:
  s_add_u32 s40, s40, 262144
  s_add_u32 s41, s41, 81920
  s_add_u32 s35, s35, 1
  s_cmp_lt_u32 s35, 64
  s_cbranch_scc1 Lg3_seg
  s_waitcnt vmcnt(0)
  s_cmp_lg_u32 s34, 0
  s_cbranch_scc1 Lg3_done
Lg3_done:
  s_endpgm
Lexit:
  s_endpgm

.section .rodata,"a"
.p2align 6
.amdhsa_kernel concat_heads__memory_aug_recurrent_mem_tr__memory_aug_recurrent_mem_tr__prompt_kernel
  .amdhsa_next_free_vgpr 512
  .amdhsa_next_free_sgpr 102
  .amdhsa_accum_offset 256
  .amdhsa_group_segment_fixed_size 0
  .amdhsa_kernarg_size 136
  .amdhsa_user_sgpr_count 2
  .amdhsa_user_sgpr_kernarg_segment_ptr 1
  .amdhsa_system_sgpr_workgroup_id_x 1
.end_amdhsa_kernel
```
